```python
import torch

def _softmax(x, axis=-1):
    return torch.softmax(x, dim=axis)
def _gelu(x):
    return torch.nn.functional.gelu(x, approximate="tanh")
def _silu(x):
    return torch.nn.functional.silu(x)
def _sigmoid(x):
    return torch.sigmoid(x)
def _layernorm(x, axis=-1, eps=1e-5):
    m = x.mean(dim=axis, keepdim=True)
    v = x.var(dim=axis, keepdim=True, unbiased=False)
    return (x - m) / torch.sqrt(v + eps)
def _scatter_add(tgt, idx, src, axis=0):
    return tgt.clone().index_add_(axis, idx, src)
def _segment_sum(src, seg, n):
    out = torch.zeros((n,) + src.shape[1:], dtype=src.dtype)
    return out.index_add_(0, seg, src)
def _pad(x, pw):
    flat = tuple(v for pair in reversed(pw) for v in pair)
    return torch.nn.functional.pad(x, flat)

kernel_name = 'recurrent_scan__softmax_full_mha__dense_activation_squared_relu__prompt'

def setup_inputs():

    _w = (lambda a: (lambda t: t.to(torch.bfloat16) if t.is_floating_point() else t)(torch.as_tensor(a)))
    def _A_setup():
        B, S, D = 1, 2048, 640
        return {
            "x": _w((lambda *s: torch.randn(*s, dtype=torch.bfloat16) * 0.05)(B, S, D)),
            "wqkv": _w((lambda *s: torch.randn(*s, dtype=torch.bfloat16) * 0.05)(D, 3 * D)),
            "wo": _w((lambda *s: torch.randn(*s, dtype=torch.bfloat16) * 0.05)(D, D)),
        }
    _A_in = _A_setup()

    def _B_setup():
        B, S, D, F = 1, 2048, 640, 1536
        return {
            "x": _w((lambda *s: torch.randn(*s, dtype=torch.bfloat16) * 0.05)(B, S, D)),
            "w1": _w((lambda *s: torch.randn(*s, dtype=torch.bfloat16) * 0.05)(D, F)),
            "b1": _w((lambda *s: torch.randn(*s, dtype=torch.bfloat16) * 0.8)(F)),
            "w2": _w((lambda *s: torch.randn(*s, dtype=torch.bfloat16) * 0.05)(F, D)),
            "b2": _w((lambda *s: torch.randn(*s, dtype=torch.bfloat16) * 3.2)(D)),
        }
    _B_in = _B_setup()

    return {
        "A_x": _A_in["x"],
        "A_wqkv": _A_in["wqkv"],
        "A_wo": _A_in["wo"],
        "B_x": _B_in["x"],
        "B_w1": _B_in["w1"],
        "B_b1": _B_in["b1"],
        "B_w2": _B_in["w2"],
        "B_b2": _B_in["b2"],
    }

def reference(A_x, A_wqkv, A_wo, B_x, B_w1, B_b1, B_w2, B_b2):
    def _A_ref(x, wqkv, wo):
        B, S, D = x.shape
        H = 32; Dh = D // H
        qkv = (lambda x, *d: x.permute(*d))((x @ wqkv).reshape(B, S, 3, H, Dh), 2, 0, 3, 1, 4)
        q, k, v = qkv[0], qkv[1], qkv[2]
        scale = Dh ** -0.5
        scores = torch.einsum("bhqd,bhkd->bhqk", q, k) * scale
        p = _softmax(scores, axis=-1)
        o = torch.einsum("bhqk,bhkd->bhqd", p, v)
        return (lambda x, *d: x.permute(*d))(o, 0, 2, 1, 3).reshape(B, S, D) @ wo

    def _B_ref(x, w1, b1, w2, b2):
        h = torch.einsum("bsd,df->bsf", x, w1) + b1
        zero = torch.zeros_like(h)
        r = torch.where(h > zero, h, zero)
        h = r * r
        out = torch.einsum("bsf,fd->bsd", h, w2) + b2
        return out

    x = A_x
    xn = _layernorm(x, axis=-1)
    s = _A_ref(xn, A_wqkv, A_wo)
    g = _silu(_B_ref(xn, B_w1, B_b1, B_w2, B_b2))
    return x + s * g
```

```asm
; @launch grid=(256,1,1) block=(768,1,1) lds=163840
.amdgcn_target "amdgcn-amd-amdhsa--gfx950"
.text
.globl recurrent_scan__softmax_full_mha__dense_activation_squared_relu__prompt_kernel
.p2align 8
.type recurrent_scan__softmax_full_mha__dense_activation_squared_relu__prompt_kernel,@function
recurrent_scan__softmax_full_mha__dense_activation_squared_relu__prompt_kernel:

    s_cmp_ge_u32 s2, 256
    s_cbranch_scc1 .end1
    s_load_dwordx16 s[64:79], s[0:1], 0
    s_load_dwordx4 s[80:83], s[0:1], 64
    s_load_dwordx2 s[84:85], s[0:1], 80
    v_lshrrev_b32 v1, 6, v0
    v_and_b32 v158, 63, v0
    v_readfirstlane_b32 s24, v1
    s_and_b32 s26, s2, 7
    s_lshr_b32 s27, s2, 3
    s_xor_b32 s32, s24, 3
    s_or_b32 s32, s32, s2
    s_cbranch_scc1 .Lnononce
    s_memrealtime s[36:37]
    v_mov_b32 v1, 0
    s_waitcnt lgkmcnt(0)
    s_mov_b32 s20, s82
    s_mov_b32 s21, s83
    s_mov_b32 s22, 256
    s_mov_b32 s23, 0x20000
    v_or_b32 v2, s36, 1
    s_mov_b64 exec, 1
    buffer_store_dword v2, v1, s[20:23], 0 offen sc1
    s_mov_b64 exec, -1
.Lnononce:
    s_lshr_b32 s32, s2, 4
    s_lshr_b32 s33, s24, 2
    s_or_b32 s32, s32, s33
    s_cbranch_scc1 .cp16
    s_getpc_b64 s[12:13]
.Lpcanchor:
    s_sub_u32 s12, s12, .Lpcanchor-recurrent_scan__softmax_full_mha__dense_activation_squared_relu__prompt_kernel
    s_subb_u32 s13, s13, 0
    s_mov_b32 s14, .cend9-recurrent_scan__softmax_full_mha__dense_activation_squared_relu__prompt_kernel
    s_mov_b32 s15, 0x20000
    v_lshlrev_b32 v3, 7, v0
    buffer_load_dword v4, v3, s[12:15], 0 offen
.cp16:
    s_add_u32 s27, s27, 30
    s_and_b32 s27, s27, 31
    s_lshr_b32 s32, s26, 1
    s_mul_i32 s33, s32, 30
    s_add_u32 s33, s33, s27
    s_and_b32 s28, s26, 1
    s_lshl_b32 s28, s28, 3
    s_and_b32 s34, s33, 7
    s_add_u32 s28, s28, s34
    s_lshr_b32 s29, s33, 3
    s_mul_i32 s30, s32, 3
    s_lshr_b32 s34, s27, 3
    s_add_u32 s30, s30, s34
    s_add_u32 s30, s30, 15
    s_lshl3_add_u32 s89, s27, s26
    s_and_b32 s25, s24, 3
    s_mul_i32 s57, s28, 3
    s_mul_i32 s34, s29, 7
    s_add_u32 s57, s57, s34
    s_mul_i32 s34, s57, 6554
    s_lshr_b32 s34, s34, 16
    s_mul_i32 s34, s34, 10
    s_sub_u32 s57, s57, s34
    s_mov_b32 s56, 524288
    v_lshlrev_b32 v161, 4, v158
    v_lshlrev_b32 v167, 3, v158
    v_mov_b32 v166, 0
    v_mov_b32 v149, 0
    v_and_b32 v159, 31, v158
    v_lshrrev_b32 v160, 5, v158
    s_cmp_lt_u32 s24, 8
    s_cbranch_scc1 .ld3
    s_setprio 3
    v_lshrrev_b32 v13, 4, v158
    v_bfe_u32 v11, v158, 2, 2
    s_lshl_b32 s32, s25, 4
    v_add_u32 v11, s32, v11
    v_and_b32 v12, 3, v158
    v_lshlrev_b32 v12, 4, v12
    v_lshl_add_u32 v12, v13, 6, v12
    s_lshl_b32 s32, s29, 8
    v_mul_u32_u24 v6, 3840, v11
    v_add3_u32 v6, v6, v12, s32
    v_add_u32 v7, 14336, v6
    v_xor_b32 v9, 32, v6
    v_add_u32 v8, 28672, v9
    v_add_u32 v9, 43008, v9
    s_lshl_b32 s32, s28, 2
    s_add_u32 s32, s32, s25
    s_lshl_b32 s32, s32, 5
    v_lshrrev_b32 v14, 3, v158
    v_add_u32 v14, s32, v14
    v_mul_u32_u24 v14, 1280, v14
    v_and_b32 v15, 7, v158
    v_xor_b32 v15, v15, v13
    v_lshl_add_u32 v2, v15, 4, v14
    v_xor_b32 v3, 64, v2
    v_add_u32 v4, 18432, v2
    v_add_u32 v5, 27648, v3
    v_add_u32 v3, 9216, v3
    s_mul_i32 s42, s57, 245760
    s_lshl_b32 s43, s57, 7
    s_lshl_b32 s44, s25, 12
    s_mul_i32 s46, s25, 3072
    s_min_u32 s46, s46, 7168
    s_add_u32 s45, s46, 153600
    s_add_u32 s46, s46, 22269952
    s_add_u32 m0, s44, 98304
    s_waitcnt lgkmcnt(0)
    s_mov_b32 s16, s66
    s_mov_b32 s17, s67
    s_mov_b32 s18, 2457600
    s_mov_b32 s19, 0x20000
    s_mov_b32 s12, s64
    s_mov_b32 s13, s65
    s_mov_b32 s14, 2621440
    s_mov_b32 s15, 0x20000
    s_mov_b32 s8, s84
    s_mov_b32 s9, s85
    s_mov_b32 s10, 22837248
    s_mov_b32 s11, 0x20000
    s_cmp_ge_u32 s89, 240
    s_cbranch_scc1 .stat13
    buffer_load_dwordx4 v6, s[16:19], s42 offen offset:0 lds
    buffer_load_dwordx4 v7, s[16:19], s42 offen offset:1024 lds
    buffer_load_dwordx4 v8, s[16:19], s42 offen offset:2048 lds
    buffer_load_dwordx4 v9, s[16:19], s42 offen offset:3072 lds
    s_add_u32 m0, s44, 65536
    s_add_u32 s42, s42, 245760
    s_cmp_eq_u32 s42, 2457600
    s_cselect_b32 s42, 0, s42
    s_mov_b32 s33, s43
    s_add_u32 s43, s43, 128
    s_cmp_eq_u32 s43, 1280
    s_cselect_b32 s43, 0, s43
    buffer_load_dwordx4 v2, s[12:15], s33 offen offset:0 lds
    buffer_load_dwordx4 v3, s[12:15], s33 offen offset:1024 lds
    buffer_load_dwordx4 v4, s[12:15], s33 offen offset:2048 lds
    buffer_load_dwordx4 v5, s[12:15], s33 offen offset:3072 lds
    s_add_u32 m0, s44, 114688
    buffer_load_dwordx4 v6, s[16:19], s42 offen offset:0 lds
    buffer_load_dwordx4 v7, s[16:19], s42 offen offset:1024 lds
    buffer_load_dwordx4 v8, s[16:19], s42 offen offset:2048 lds
    buffer_load_dwordx4 v9, s[16:19], s42 offen offset:3072 lds
    s_add_u32 m0, s44, 81920
    s_add_u32 s42, s42, 245760
    s_cmp_eq_u32 s42, 2457600
    s_cselect_b32 s42, 0, s42
    s_mov_b32 s33, s43
    s_add_u32 s43, s43, 128
    s_cmp_eq_u32 s43, 1280
    s_cselect_b32 s43, 0, s43
    buffer_load_dwordx4 v2, s[12:15], s33 offen offset:0 lds
    buffer_load_dwordx4 v3, s[12:15], s33 offen offset:1024 lds
    buffer_load_dwordx4 v4, s[12:15], s33 offen offset:2048 lds
    buffer_load_dwordx4 v5, s[12:15], s33 offen offset:3072 lds
    s_add_u32 m0, s44, 131072
    s_setprio 0
    s_waitcnt vmcnt(8)
    s_barrier
    buffer_load_dwordx4 v6, s[16:19], s42 offen offset:0 lds
    buffer_load_dwordx4 v7, s[16:19], s42 offen offset:1024 lds
    buffer_load_dwordx4 v8, s[16:19], s42 offen offset:2048 lds
    buffer_load_dwordx4 v9, s[16:19], s42 offen offset:3072 lds
    s_add_u32 m0, s44, 0
    s_add_u32 s42, s42, 245760
    s_cmp_eq_u32 s42, 2457600
    s_cselect_b32 s42, 0, s42
    s_mov_b32 s33, s43
    s_add_u32 s43, s43, 128
    s_cmp_eq_u32 s43, 1280
    s_cselect_b32 s43, 0, s43
    buffer_load_dwordx4 v2, s[12:15], s33 offen offset:0 lds
    buffer_load_dwordx4 v3, s[12:15], s33 offen offset:1024 lds
    buffer_load_dwordx4 v4, s[12:15], s33 offen offset:2048 lds
    buffer_load_dwordx4 v5, s[12:15], s33 offen offset:3072 lds
    s_add_u32 m0, s44, 98304
    s_waitcnt vmcnt(8)
    s_barrier
    buffer_load_dwordx4 v6, s[16:19], s42 offen offset:0 lds
    buffer_load_dwordx4 v7, s[16:19], s42 offen offset:1024 lds
    buffer_load_dwordx4 v8, s[16:19], s42 offen offset:2048 lds
    buffer_load_dwordx4 v9, s[16:19], s42 offen offset:3072 lds
    s_add_u32 m0, s44, 16384
    s_add_u32 s42, s42, 245760
    s_cmp_eq_u32 s42, 2457600
    s_cselect_b32 s42, 0, s42
    s_mov_b32 s33, s43
    s_add_u32 s43, s43, 128
    s_cmp_eq_u32 s43, 1280
    s_cselect_b32 s43, 0, s43
    buffer_load_dwordx4 v2, s[12:15], s33 offen offset:0 lds
    buffer_load_dwordx4 v3, s[12:15], s33 offen offset:1024 lds
    buffer_load_dwordx4 v4, s[12:15], s33 offen offset:2048 lds
    buffer_load_dwordx4 v5, s[12:15], s33 offen offset:3072 lds
    s_add_u32 m0, s44, 114688
    s_waitcnt vmcnt(8)
    s_barrier
    buffer_load_dwordx4 v6, s[16:19], s42 offen offset:0 lds
    buffer_load_dwordx4 v7, s[16:19], s42 offen offset:1024 lds
    buffer_load_dwordx4 v8, s[16:19], s42 offen offset:2048 lds
    buffer_load_dwordx4 v9, s[16:19], s42 offen offset:3072 lds
    s_add_u32 m0, s44, 32768
    s_add_u32 s42, s42, 245760
    s_cmp_eq_u32 s42, 2457600
    s_cselect_b32 s42, 0, s42
    s_mov_b32 s33, s43
    s_add_u32 s43, s43, 128
    s_cmp_eq_u32 s43, 1280
    s_cselect_b32 s43, 0, s43
    buffer_load_dwordx4 v2, s[12:15], s33 offen offset:0 lds
    buffer_load_dwordx4 v3, s[12:15], s33 offen offset:1024 lds
    buffer_load_dwordx4 v4, s[12:15], s33 offen offset:2048 lds
    buffer_load_dwordx4 v5, s[12:15], s33 offen offset:3072 lds
    s_add_u32 m0, s44, 131072
    s_waitcnt vmcnt(8)
    s_barrier
    buffer_load_dwordx4 v6, s[16:19], s42 offen offset:0 lds
    buffer_load_dwordx4 v7, s[16:19], s42 offen offset:1024 lds
    buffer_load_dwordx4 v8, s[16:19], s42 offen offset:2048 lds
    buffer_load_dwordx4 v9, s[16:19], s42 offen offset:3072 lds
    s_add_u32 m0, s44, 49152
    s_add_u32 s42, s42, 245760
    s_cmp_eq_u32 s42, 2457600
    s_cselect_b32 s42, 0, s42
    s_mov_b32 s33, s43
    s_add_u32 s43, s43, 128
    s_cmp_eq_u32 s43, 1280
    s_cselect_b32 s43, 0, s43
    buffer_load_dwordx4 v2, s[12:15], s33 offen offset:0 lds
    buffer_load_dwordx4 v3, s[12:15], s33 offen offset:1024 lds
    buffer_load_dwordx4 v4, s[12:15], s33 offen offset:2048 lds
    buffer_load_dwordx4 v5, s[12:15], s33 offen offset:3072 lds
    s_add_u32 m0, s44, 98304
    s_waitcnt vmcnt(8)
    s_barrier
    buffer_load_dwordx4 v6, s[16:19], s42 offen offset:0 lds
    buffer_load_dwordx4 v7, s[16:19], s42 offen offset:1024 lds
    buffer_load_dwordx4 v8, s[16:19], s42 offen offset:2048 lds
    buffer_load_dwordx4 v9, s[16:19], s42 offen offset:3072 lds
    s_add_u32 m0, s44, 65536
    s_add_u32 s42, s42, 245760
    s_cmp_eq_u32 s42, 2457600
    s_cselect_b32 s42, 0, s42
    s_mov_b32 s33, s43
    s_add_u32 s43, s43, 128
    s_cmp_eq_u32 s43, 1280
    s_cselect_b32 s43, 0, s43
    buffer_load_dwordx4 v2, s[12:15], s33 offen offset:0 lds
    buffer_load_dwordx4 v3, s[12:15], s33 offen offset:1024 lds
    buffer_load_dwordx4 v4, s[12:15], s33 offen offset:2048 lds
    buffer_load_dwordx4 v5, s[12:15], s33 offen offset:3072 lds
    s_add_u32 m0, s44, 114688
    s_waitcnt vmcnt(8)
    s_barrier
    buffer_load_dwordx4 v6, s[16:19], s42 offen offset:0 lds
    buffer_load_dwordx4 v7, s[16:19], s42 offen offset:1024 lds
    buffer_load_dwordx4 v8, s[16:19], s42 offen offset:2048 lds
    buffer_load_dwordx4 v9, s[16:19], s42 offen offset:3072 lds
    s_add_u32 m0, s44, 81920
    s_add_u32 s42, s42, 245760
    s_cmp_eq_u32 s42, 2457600
    s_cselect_b32 s42, 0, s42
    s_mov_b32 s33, s43
    s_add_u32 s43, s43, 128
    s_cmp_eq_u32 s43, 1280
    s_cselect_b32 s43, 0, s43
    buffer_load_dwordx4 v2, s[12:15], s33 offen offset:0 lds
    buffer_load_dwordx4 v3, s[12:15], s33 offen offset:1024 lds
    buffer_load_dwordx4 v4, s[12:15], s33 offen offset:2048 lds
    buffer_load_dwordx4 v5, s[12:15], s33 offen offset:3072 lds
    s_add_u32 m0, s44, 131072
    s_waitcnt vmcnt(8)
    s_barrier
    buffer_load_dwordx4 v6, s[16:19], s42 offen offset:0 lds
    buffer_load_dwordx4 v7, s[16:19], s42 offen offset:1024 lds
    buffer_load_dwordx4 v8, s[16:19], s42 offen offset:2048 lds
    buffer_load_dwordx4 v9, s[16:19], s42 offen offset:3072 lds
    s_add_u32 m0, s44, 0
    s_add_u32 s42, s42, 245760
    s_cmp_eq_u32 s42, 2457600
    s_cselect_b32 s42, 0, s42
    s_mov_b32 s33, s43
    s_add_u32 s43, s43, 128
    s_cmp_eq_u32 s43, 1280
    s_cselect_b32 s43, 0, s43
    buffer_load_dwordx4 v2, s[12:15], s33 offen offset:0 lds
    buffer_load_dwordx4 v3, s[12:15], s33 offen offset:1024 lds
    buffer_load_dwordx4 v4, s[12:15], s33 offen offset:2048 lds
    buffer_load_dwordx4 v5, s[12:15], s33 offen offset:3072 lds
    s_mov_b32 m0, s45
    s_mul_i32 s32, s29, 10240
    s_add_u32 s32, s32, s46
    buffer_load_dwordx4 v161, s[8:11], s32 offen offset:0 sc1 lds
    buffer_load_dwordx4 v161, s[8:11], s32 offen offset:1024 sc1 lds
    buffer_load_dwordx4 v161, s[8:11], s32 offen offset:2048 sc1 lds
    s_add_u32 m0, s44, 98304
    s_waitcnt vmcnt(11)
    s_barrier
    buffer_load_dwordx4 v6, s[16:19], s42 offen offset:0 lds
    buffer_load_dwordx4 v7, s[16:19], s42 offen offset:1024 lds
    buffer_load_dwordx4 v8, s[16:19], s42 offen offset:2048 lds
    buffer_load_dwordx4 v9, s[16:19], s42 offen offset:3072 lds
    s_add_u32 m0, s44, 16384
    s_mov_b32 s20, s72
    s_mov_b32 s21, s73
    s_mov_b32 s22, 1966080
    s_mov_b32 s23, 0x20000
    s_add_u32 s42, s57, 4
    s_cmp_ge_u32 s42, 10
    s_cselect_b32 s32, 10, 0
    s_sub_u32 s42, s42, s32
    s_mul_i32 s42, s42, 196608
    s_sub_u32 s32, s30, 15
    s_lshl_b32 s32, s32, 8
    v_mul_u32_u24 v6, 3072, v11
    v_add3_u32 v6, v6, v12, s32
    v_add_u32 v7, 11264, v6
    v_xor_b32 v9, 32, v6
    v_add_u32 v8, 22528, v9
    v_add_u32 v9, 33792, v9
    s_mov_b32 s33, s43
    s_add_u32 s43, s43, 128
    s_cmp_eq_u32 s43, 1280
    s_cselect_b32 s43, 0, s43
    buffer_load_dwordx4 v2, s[12:15], s33 offen offset:0 lds
    buffer_load_dwordx4 v3, s[12:15], s33 offen offset:1024 lds
    buffer_load_dwordx4 v4, s[12:15], s33 offen offset:2048 lds
    buffer_load_dwordx4 v5, s[12:15], s33 offen offset:3072 lds
    s_and_b32 s32, s25, 1
    s_lshl_b32 s32, s32, 10
    s_add_u32 m0, s32, 151552
    s_lshl_b32 s33, s28, 11
    s_add_u32 s33, s33, s32
    s_add_u32 s33, s33, 22237184
    buffer_load_dwordx4 v161, s[8:11], s33 offen sc1 lds
    s_add_u32 m0, s44, 114688
    s_waitcnt vmcnt(9)
    s_cmp_ge_u32 s89, 192
    s_cbranch_scc1 .lonlya17
    s_barrier
    buffer_load_dwordx4 v6, s[20:23], s42 offen offset:0 lds
    buffer_load_dwordx4 v7, s[20:23], s42 offen offset:1024 lds
    buffer_load_dwordx4 v8, s[20:23], s42 offen offset:2048 lds
    buffer_load_dwordx4 v9, s[20:23], s42 offen offset:3072 lds
    s_add_u32 m0, s44, 131072
    s_add_u32 s42, s42, 196608
    s_cmp_eq_u32 s42, 1966080
    s_cselect_b32 s42, 0, s42
    s_waitcnt vmcnt(4)
    s_barrier
    buffer_load_dwordx4 v6, s[20:23], s42 offen offset:0 lds
    buffer_load_dwordx4 v7, s[20:23], s42 offen offset:1024 lds
    buffer_load_dwordx4 v8, s[20:23], s42 offen offset:2048 lds
    buffer_load_dwordx4 v9, s[20:23], s42 offen offset:3072 lds
    s_add_u32 m0, s44, 98304
    s_add_u32 s42, s42, 196608
    s_cmp_eq_u32 s42, 1966080
    s_cselect_b32 s42, 0, s42
    s_waitcnt vmcnt(4)
    s_barrier
    buffer_load_dwordx4 v6, s[20:23], s42 offen offset:0 lds
    buffer_load_dwordx4 v7, s[20:23], s42 offen offset:1024 lds
    buffer_load_dwordx4 v8, s[20:23], s42 offen offset:2048 lds
    buffer_load_dwordx4 v9, s[20:23], s42 offen offset:3072 lds
    s_add_u32 m0, s44, 114688
    s_add_u32 s42, s42, 196608
    s_cmp_eq_u32 s42, 1966080
    s_cselect_b32 s42, 0, s42
    s_waitcnt vmcnt(4)
    s_barrier
    buffer_load_dwordx4 v6, s[20:23], s42 offen offset:0 lds
    buffer_load_dwordx4 v7, s[20:23], s42 offen offset:1024 lds
    buffer_load_dwordx4 v8, s[20:23], s42 offen offset:2048 lds
    buffer_load_dwordx4 v9, s[20:23], s42 offen offset:3072 lds
    s_add_u32 m0, s44, 131072
    s_add_u32 s42, s42, 196608
    s_cmp_eq_u32 s42, 1966080
    s_cselect_b32 s42, 0, s42
    s_waitcnt vmcnt(4)
    s_barrier
    buffer_load_dwordx4 v6, s[20:23], s42 offen offset:0 lds
    buffer_load_dwordx4 v7, s[20:23], s42 offen offset:1024 lds
    buffer_load_dwordx4 v8, s[20:23], s42 offen offset:2048 lds
    buffer_load_dwordx4 v9, s[20:23], s42 offen offset:3072 lds
    s_add_u32 m0, s44, 98304
    s_add_u32 s42, s42, 196608
    s_cmp_eq_u32 s42, 1966080
    s_cselect_b32 s42, 0, s42
    s_waitcnt vmcnt(4)
    s_barrier
    buffer_load_dwordx4 v6, s[20:23], s42 offen offset:0 lds
    buffer_load_dwordx4 v7, s[20:23], s42 offen offset:1024 lds
    buffer_load_dwordx4 v8, s[20:23], s42 offen offset:2048 lds
    buffer_load_dwordx4 v9, s[20:23], s42 offen offset:3072 lds
    s_add_u32 m0, s44, 32768
    s_add_u32 s42, s42, 196608
    s_cmp_eq_u32 s42, 1966080
    s_cselect_b32 s42, 0, s42
    s_mov_b32 s33, s43
    s_add_u32 s43, s43, 128
    s_cmp_eq_u32 s43, 1280
    s_cselect_b32 s43, 0, s43
    buffer_load_dwordx4 v2, s[12:15], s33 offen offset:0 lds
    buffer_load_dwordx4 v3, s[12:15], s33 offen offset:1024 lds
    buffer_load_dwordx4 v4, s[12:15], s33 offen offset:2048 lds
    buffer_load_dwordx4 v5, s[12:15], s33 offen offset:3072 lds
    s_add_u32 m0, s44, 114688
    s_waitcnt vmcnt(8)
    s_barrier
    buffer_load_dwordx4 v6, s[20:23], s42 offen offset:0 lds
    buffer_load_dwordx4 v7, s[20:23], s42 offen offset:1024 lds
    buffer_load_dwordx4 v8, s[20:23], s42 offen offset:2048 lds
    buffer_load_dwordx4 v9, s[20:23], s42 offen offset:3072 lds
    s_add_u32 m0, s44, 49152
    s_add_u32 s42, s42, 196608
    s_cmp_eq_u32 s42, 1966080
    s_cselect_b32 s42, 0, s42
    s_mov_b32 s33, s43
    s_add_u32 s43, s43, 128
    s_cmp_eq_u32 s43, 1280
    s_cselect_b32 s43, 0, s43
    buffer_load_dwordx4 v2, s[12:15], s33 offen offset:0 lds
    buffer_load_dwordx4 v3, s[12:15], s33 offen offset:1024 lds
    buffer_load_dwordx4 v4, s[12:15], s33 offen offset:2048 lds
    buffer_load_dwordx4 v5, s[12:15], s33 offen offset:3072 lds
    s_mov_b32 m0, s45
    s_mul_i32 s32, s30, 10240
    s_add_u32 s32, s32, s46
    buffer_load_dwordx4 v161, s[8:11], s32 offen offset:0 sc1 lds
    buffer_load_dwordx4 v161, s[8:11], s32 offen offset:1024 sc1 lds
    buffer_load_dwordx4 v161, s[8:11], s32 offen offset:2048 sc1 lds
    s_add_u32 m0, s44, 131072
    s_waitcnt vmcnt(15)
    s_barrier
    buffer_load_dwordx4 v6, s[20:23], s42 offen offset:0 lds
    buffer_load_dwordx4 v7, s[20:23], s42 offen offset:1024 lds
    buffer_load_dwordx4 v8, s[20:23], s42 offen offset:2048 lds
    buffer_load_dwordx4 v9, s[20:23], s42 offen offset:3072 lds
    s_add_u32 m0, s44, 65536
    s_add_u32 s42, s42, 196608
    s_cmp_eq_u32 s42, 1966080
    s_cselect_b32 s42, 0, s42
    s_mov_b32 s33, s43
    s_add_u32 s43, s43, 128
    s_cmp_eq_u32 s43, 1280
    s_cselect_b32 s43, 0, s43
    buffer_load_dwordx4 v2, s[12:15], s33 offen offset:0 lds
    buffer_load_dwordx4 v3, s[12:15], s33 offen offset:1024 lds
    buffer_load_dwordx4 v4, s[12:15], s33 offen offset:2048 lds
    buffer_load_dwordx4 v5, s[12:15], s33 offen offset:3072 lds
    s_add_u32 m0, s44, 98304
    s_waitcnt vmcnt(8)
    s_barrier
    buffer_load_dwordx4 v6, s[20:23], s42 offen offset:0 lds
    buffer_load_dwordx4 v7, s[20:23], s42 offen offset:1024 lds
    buffer_load_dwordx4 v8, s[20:23], s42 offen offset:2048 lds
    buffer_load_dwordx4 v9, s[20:23], s42 offen offset:3072 lds
    s_add_u32 m0, s44, 81920
    s_add_u32 s42, s42, 196608
    s_cmp_eq_u32 s42, 1966080
    s_cselect_b32 s42, 0, s42
    s_mov_b32 s33, s43
    s_add_u32 s43, s43, 128
    s_cmp_eq_u32 s43, 1280
    s_cselect_b32 s43, 0, s43
    buffer_load_dwordx4 v2, s[12:15], s33 offen offset:0 lds
    buffer_load_dwordx4 v3, s[12:15], s33 offen offset:1024 lds
    buffer_load_dwordx4 v4, s[12:15], s33 offen offset:2048 lds
    buffer_load_dwordx4 v5, s[12:15], s33 offen offset:3072 lds
    s_add_u32 m0, s44, 114688
    s_waitcnt vmcnt(12)
    s_barrier
    buffer_load_dwordx4 v6, s[20:23], s42 offen offset:0 lds
    buffer_load_dwordx4 v7, s[20:23], s42 offen offset:1024 lds
    buffer_load_dwordx4 v8, s[20:23], s42 offen offset:2048 lds
    buffer_load_dwordx4 v9, s[20:23], s42 offen offset:3072 lds
    s_add_u32 s42, s42, 196608
    s_cmp_eq_u32 s42, 1966080
    s_cselect_b32 s42, 0, s42
    s_waitcnt vmcnt(8)
    s_barrier
    s_waitcnt vmcnt(0)
    s_barrier
    v_mov_b32 v10, 148992
    ds_read_b32 v10, v10
    s_waitcnt lgkmcnt(0)
    v_readfirstlane_b32 s31, v10
.trl8:
    s_lshl_b32 s50, s26, 2
    s_and_b32 s34, s27, 3
    s_add_u32 s50, s50, s34
    s_mul_i32 s51, s50, 163840
    s_lshr_b32 s53, s26, 1
    s_lshl_b32 s53, s53, 4
    s_and_b32 s34, s27, 15
    s_add_u32 s53, s53, s34
    s_and_b32 s54, s26, 1
    s_lshl_b32 s54, s54, 1
    s_lshr_b32 s34, s27, 4
    s_add_u32 s54, s54, s34
    v_mov_b32 v0, 0
    v_mov_b32 v1, 0
    v_mov_b32 v2, 0
    v_mov_b32 v3, 0
    v_mov_b32 v4, 0
    v_mov_b32 v5, 0
    v_mov_b32 v6, 0
    v_mov_b32 v7, 0
    v_mov_b32 v8, 0
    v_mov_b32 v9, 0
    v_mov_b32 v10, 0
    v_mov_b32 v11, 0
    v_mov_b32 v12, 0
    v_mov_b32 v13, 0
    v_mov_b32 v14, 0
    v_mov_b32 v15, 0
    v_mov_b32 v16, 0
    v_mov_b32 v17, 0
    v_mov_b32 v18, 0
    v_mov_b32 v19, 0
    v_mov_b32 v20, 0
    v_mov_b32 v21, 0
    v_mov_b32 v22, 0
    v_mov_b32 v23, 0
    v_mov_b32 v24, 0
    v_mov_b32 v25, 0
    v_mov_b32 v26, 0
    v_mov_b32 v27, 0
    v_mov_b32 v28, 0
    v_mov_b32 v29, 0
    v_mov_b32 v30, 0
    v_mov_b32 v31, 0
    v_mov_b32 v32, 0
    v_mov_b32 v33, 0
    v_mov_b32 v34, 0
    v_mov_b32 v35, 0
    v_mov_b32 v36, 0
    v_mov_b32 v37, 0
    v_mov_b32 v38, 0
    v_mov_b32 v39, 0
    v_mov_b32 v40, 0
    v_mov_b32 v41, 0
    v_mov_b32 v42, 0
    v_mov_b32 v43, 0
    v_mov_b32 v44, 0
    v_mov_b32 v45, 0
    v_mov_b32 v46, 0
    v_mov_b32 v47, 0
    v_mov_b32 v48, 0
    v_mov_b32 v49, 0
    v_mov_b32 v50, 0
    v_mov_b32 v51, 0
    v_mov_b32 v52, 0
    v_mov_b32 v53, 0
    v_mov_b32 v54, 0
    v_mov_b32 v55, 0
    v_mov_b32 v56, 0
    v_mov_b32 v57, 0
    v_mov_b32 v58, 0
    v_mov_b32 v59, 0
    v_mov_b32 v60, 0
    v_mov_b32 v61, 0
    v_mov_b32 v62, 0
    v_mov_b32 v63, 0
    v_mov_b32 v64, 0
    v_mov_b32 v65, 0
    v_mov_b32 v66, 0
    v_mov_b32 v67, 0
    v_mov_b32 v68, 0
    v_mov_b32 v69, 0
    v_mov_b32 v70, 0
    v_mov_b32 v71, 0
    v_mov_b32 v72, 0
    v_mov_b32 v73, 0
    v_mov_b32 v74, 0
    v_mov_b32 v75, 0
    v_mov_b32 v76, 0
    v_mov_b32 v77, 0
    v_mov_b32 v78, 0
    v_mov_b32 v79, 0
    s_mul_i32 s42, s53, 98304
    s_mul_i32 s34, s25, 24576
    s_add_u32 s42, s42, s34
    s_add_u32 s42, s42, 7864320
    s_mul_i32 s43, s25, 491520
    s_mul_i32 s34, s54, 5120
    s_add_u32 s43, s43, s34
    s_add_u32 s43, s43, 14155776
    v_add_u32 v136, 4096, v161
    v_min_u32 v138, 23, v158
    v_lshlrev_b32 v138, 6, v138
    s_lshr_b32 s44, s53, 1
    s_lshl_b32 s44, s44, 11
    s_add_u32 s44, s44, 22607872
    v_lshlrev_b32 v139, 6, v158
    s_mov_b32 s46, 22673408
    s_lshl_b32 s45, s25, 10
    s_add_u32 s45, s45, 20480
    s_mov_b32 m0, s45
    s_add_u32 s45, s45, s51
    s_mov_b32 s38, 0
    s_mov_b32 s47, 2048
    s_lshl_b32 s32, s25, 2
    s_add_u32 s32, s32, 149056
    v_mov_b32 v142, s32
    v_mov_b32 v143, s31
    s_barrier
    s_setprio 3
.kv18:
    buffer_load_dwordx4 v161, s[8:11], s45 offen sc1 lds
    s_waitcnt vmcnt(6)
    s_add_u32 m0, m0, 4096
    s_add_u32 s45, s45, 4096
    s_add_u32 s38, s38, 1
    s_bitcmp1_b32 s47, s38
    s_cbranch_scc0 .kvb19
    ds_write_b32 v142, v143
    v_add_u32 v142, 16, v142
.kvb19:
    s_cmp_lt_u32 s38, 31
    s_cbranch_scc1 .kv18
    buffer_load_dword v140, v139, s[8:11], s46 offen sc1
    s_waitcnt vmcnt(0)
.pollc21:
    v_xor_b32 v140, s31, v140
    v_cmp_ne_u32 vcc, 0, v140
    s_nop 0
    s_cmp_lg_u64 vcc, 0
    s_cbranch_scc1 .poll20
.polld22:
    ds_write_b32 v142, v143
    buffer_load_dword v140, v138, s[8:11], s44 offen sc1
    s_waitcnt vmcnt(0)
.pollc24:
    v_xor_b32 v140, s31, v140
    v_cmp_ne_u32 vcc, 0, v140
    s_nop 0
    s_cmp_lg_u64 vcc, 0
    s_cbranch_scc1 .poll23
.polld25:
    v_lshlrev_b32 v138, 6, v159
    s_lshr_b32 s46, s53, 1
    s_lshl_b32 s46, s46, 11
    s_add_u32 s46, s46, 22706176
    v_and_b32 v140, 15, v158
    v_lshlrev_b32 v140, 4, v140
    v_lshrrev_b32 v141, 4, v158
    v_lshl_add_u32 v141, v141, 9, v140
    v_mul_u32_u24 v137, 19456, v160
    v_add_u32 v137, v137, v141
    v_add_u32 v136, 4096, v137
    buffer_load_dwordx4 v[80:83], v141, s[8:11], s42 offen offset:0 sc1
    buffer_load_dwordx4 v[84:87], v141, s[8:11], s42 offen offset:256 sc1
    buffer_load_dwordx4 v[96:99], v137, s[8:11], s43 offen offset:0 sc1
    buffer_load_dwordx4 v[100:103], v137, s[8:11], s43 offen offset:1024 sc1
    buffer_load_dwordx4 v[104:107], v137, s[8:11], s43 offen offset:2048 sc1
    buffer_load_dwordx4 v[108:111], v137, s[8:11], s43 offen offset:3072 sc1
    buffer_load_dwordx4 v[112:115], v136, s[8:11], s43 offen offset:0 sc1
    buffer_load_dwordx4 v[116:119], v137, s[8:11], s43 offen offset:256 sc1
    buffer_load_dwordx4 v[120:123], v137, s[8:11], s43 offen offset:1280 sc1
    buffer_load_dwordx4 v[124:127], v137, s[8:11], s43 offen offset:2304 sc1
    buffer_load_dwordx4 v[128:131], v137, s[8:11], s43 offen offset:3328 sc1
    buffer_load_dwordx4 v[132:135], v136, s[8:11], s43 offen offset:256 sc1
    s_add_u32 s43, s43, 40960
    buffer_load_dwordx4 v[88:91], v141, s[8:11], s42 offen offset:2048 sc1
    buffer_load_dwordx4 v[92:95], v141, s[8:11], s42 offen offset:2304 sc1
    s_add_u32 s42, s42, 4096
    s_mov_b32 s38, 0
.ffn26:
    s_waitcnt vmcnt(11)
    v_mfma_f32_16x16x32_bf16 v[0:3], v[96:99], v[80:83], v[0:3]
    v_mfma_f32_16x16x32_bf16 v[4:7], v[96:99], v[84:87], v[4:7]
    buffer_load_dwordx4 v[96:99], v137, s[8:11], s43 offen offset:0 sc1
    s_waitcnt vmcnt(11)
    v_mfma_f32_16x16x32_bf16 v[16:19], v[100:103], v[80:83], v[16:19]
    v_mfma_f32_16x16x32_bf16 v[20:23], v[100:103], v[84:87], v[20:23]
    buffer_load_dwordx4 v[100:103], v137, s[8:11], s43 offen offset:1024 sc1
    s_waitcnt vmcnt(11)
    v_mfma_f32_16x16x32_bf16 v[32:35], v[104:107], v[80:83], v[32:35]
    v_mfma_f32_16x16x32_bf16 v[36:39], v[104:107], v[84:87], v[36:39]
    buffer_load_dwordx4 v[104:107], v137, s[8:11], s43 offen offset:2048 sc1
    s_waitcnt vmcnt(11)
    v_mfma_f32_16x16x32_bf16 v[48:51], v[108:111], v[80:83], v[48:51]
    v_mfma_f32_16x16x32_bf16 v[52:55], v[108:111], v[84:87], v[52:55]
    buffer_load_dwordx4 v[108:111], v137, s[8:11], s43 offen offset:3072 sc1
    s_waitcnt vmcnt(11)
    v_mfma_f32_16x16x32_bf16 v[64:67], v[112:115], v[80:83], v[64:67]
    v_mfma_f32_16x16x32_bf16 v[68:71], v[112:115], v[84:87], v[68:71]
    buffer_load_dwordx4 v[112:115], v136, s[8:11], s43 offen offset:0 sc1
    s_waitcnt vmcnt(11)
    v_mfma_f32_16x16x32_bf16 v[8:11], v[116:119], v[80:83], v[8:11]
    v_mfma_f32_16x16x32_bf16 v[12:15], v[116:119], v[84:87], v[12:15]
    buffer_load_dwordx4 v[116:119], v137, s[8:11], s43 offen offset:256 sc1
    s_waitcnt vmcnt(11)
    v_mfma_f32_16x16x32_bf16 v[24:27], v[120:123], v[80:83], v[24:27]
    v_mfma_f32_16x16x32_bf16 v[28:31], v[120:123], v[84:87], v[28:31]
    buffer_load_dwordx4 v[120:123], v137, s[8:11], s43 offen offset:1280 sc1
    s_waitcnt vmcnt(11)
    v_mfma_f32_16x16x32_bf16 v[40:43], v[124:127], v[80:83], v[40:43]
    v_mfma_f32_16x16x32_bf16 v[44:47], v[124:127], v[84:87], v[44:47]
    buffer_load_dwordx4 v[124:127], v137, s[8:11], s43 offen offset:2304 sc1
    s_waitcnt vmcnt(11)
    v_mfma_f32_16x16x32_bf16 v[56:59], v[128:131], v[80:83], v[56:59]
    v_mfma_f32_16x16x32_bf16 v[60:63], v[128:131], v[84:87], v[60:63]
    buffer_load_dwordx4 v[128:131], v137, s[8:11], s43 offen offset:3328 sc1
    s_waitcnt vmcnt(11)
    v_mfma_f32_16x16x32_bf16 v[72:75], v[132:135], v[80:83], v[72:75]
    v_mfma_f32_16x16x32_bf16 v[76:79], v[132:135], v[84:87], v[76:79]
    buffer_load_dwordx4 v[132:135], v136, s[8:11], s43 offen offset:256 sc1
    s_add_u32 s43, s43, 40960
    buffer_load_dwordx4 v[80:83], v141, s[8:11], s42 offen offset:0 sc1
    buffer_load_dwordx4 v[84:87], v141, s[8:11], s42 offen offset:256 sc1
    s_waitcnt vmcnt(11)
    v_mfma_f32_16x16x32_bf16 v[0:3], v[96:99], v[88:91], v[0:3]
    v_mfma_f32_16x16x32_bf16 v[4:7], v[96:99], v[92:95], v[4:7]
    buffer_load_dwordx4 v[96:99], v137, s[8:11], s43 offen offset:0 sc1
    s_waitcnt vmcnt(11)
    v_mfma_f32_16x16x32_bf16 v[16:19], v[100:103], v[88:91], v[16:19]
    v_mfma_f32_16x16x32_bf16 v[20:23], v[100:103], v[92:95], v[20:23]
    buffer_load_dwordx4 v[100:103], v137, s[8:11], s43 offen offset:1024 sc1
    s_waitcnt vmcnt(11)
    v_mfma_f32_16x16x32_bf16 v[32:35], v[104:107], v[88:91], v[32:35]
    v_mfma_f32_16x16x32_bf16 v[36:39], v[104:107], v[92:95], v[36:39]
    buffer_load_dwordx4 v[104:107], v137, s[8:11], s43 offen offset:2048 sc1
    s_waitcnt vmcnt(11)
    v_mfma_f32_16x16x32_bf16 v[48:51], v[108:111], v[88:91], v[48:51]
    v_mfma_f32_16x16x32_bf16 v[52:55], v[108:111], v[92:95], v[52:55]
    buffer_load_dwordx4 v[108:111], v137, s[8:11], s43 offen offset:3072 sc1
    s_waitcnt vmcnt(11)
    v_mfma_f32_16x16x32_bf16 v[64:67], v[112:115], v[88:91], v[64:67]
    v_mfma_f32_16x16x32_bf16 v[68:71], v[112:115], v[92:95], v[68:71]
    buffer_load_dwordx4 v[112:115], v136, s[8:11], s43 offen offset:0 sc1
    s_waitcnt vmcnt(11)
    v_mfma_f32_16x16x32_bf16 v[8:11], v[116:119], v[88:91], v[8:11]
    v_mfma_f32_16x16x32_bf16 v[12:15], v[116:119], v[92:95], v[12:15]
    buffer_load_dwordx4 v[116:119], v137, s[8:11], s43 offen offset:256 sc1
    s_waitcnt vmcnt(11)
    v_mfma_f32_16x16x32_bf16 v[24:27], v[120:123], v[88:91], v[24:27]
    v_mfma_f32_16x16x32_bf16 v[28:31], v[120:123], v[92:95], v[28:31]
    buffer_load_dwordx4 v[120:123], v137, s[8:11], s43 offen offset:1280 sc1
    s_waitcnt vmcnt(11)
    v_mfma_f32_16x16x32_bf16 v[40:43], v[124:127], v[88:91], v[40:43]
    v_mfma_f32_16x16x32_bf16 v[44:47], v[124:127], v[92:95], v[44:47]
    buffer_load_dwordx4 v[124:127], v137, s[8:11], s43 offen offset:2304 sc1
    s_waitcnt vmcnt(11)
    v_mfma_f32_16x16x32_bf16 v[56:59], v[128:131], v[88:91], v[56:59]
    v_mfma_f32_16x16x32_bf16 v[60:63], v[128:131], v[92:95], v[60:63]
    buffer_load_dwordx4 v[128:131], v137, s[8:11], s43 offen offset:3328 sc1
    s_waitcnt vmcnt(11)
    v_mfma_f32_16x16x32_bf16 v[72:75], v[132:135], v[88:91], v[72:75]
    v_mfma_f32_16x16x32_bf16 v[76:79], v[132:135], v[92:95], v[76:79]
    buffer_load_dwordx4 v[132:135], v136, s[8:11], s43 offen offset:256 sc1
    s_add_u32 s43, s43, 40960
    buffer_load_dwordx4 v[88:91], v141, s[8:11], s42 offen offset:2048 sc1
    buffer_load_dwordx4 v[92:95], v141, s[8:11], s42 offen offset:2304 sc1
    s_add_u32 s42, s42, 4096
    s_add_u32 s38, s38, 1
    s_cmp_lt_u32 s38, 5
    s_cbranch_scc1 .ffn26
    buffer_load_dword v139, v138, s[8:11], s46 offen sc1
    s_waitcnt vmcnt(12)
    v_mfma_f32_16x16x32_bf16 v[0:3], v[96:99], v[80:83], v[0:3]
    v_mfma_f32_16x16x32_bf16 v[4:7], v[96:99], v[84:87], v[4:7]
    buffer_load_dwordx4 v[96:99], v137, s[8:11], s43 offen offset:0 sc1
    s_waitcnt vmcnt(12)
    v_mfma_f32_16x16x32_bf16 v[16:19], v[100:103], v[80:83], v[16:19]
    v_mfma_f32_16x16x32_bf16 v[20:23], v[100:103], v[84:87], v[20:23]
    buffer_load_dwordx4 v[100:103], v137, s[8:11], s43 offen offset:1024 sc1
    s_waitcnt vmcnt(12)
    v_mfma_f32_16x16x32_bf16 v[32:35], v[104:107], v[80:83], v[32:35]
    v_mfma_f32_16x16x32_bf16 v[36:39], v[104:107], v[84:87], v[36:39]
    buffer_load_dwordx4 v[104:107], v137, s[8:11], s43 offen offset:2048 sc1
    s_waitcnt vmcnt(12)
    v_mfma_f32_16x16x32_bf16 v[48:51], v[108:111], v[80:83], v[48:51]
    v_mfma_f32_16x16x32_bf16 v[52:55], v[108:111], v[84:87], v[52:55]
    buffer_load_dwordx4 v[108:111], v137, s[8:11], s43 offen offset:3072 sc1
    s_waitcnt vmcnt(12)
    v_mfma_f32_16x16x32_bf16 v[64:67], v[112:115], v[80:83], v[64:67]
    v_mfma_f32_16x16x32_bf16 v[68:71], v[112:115], v[84:87], v[68:71]
    buffer_load_dwordx4 v[112:115], v136, s[8:11], s43 offen offset:0 sc1
    s_waitcnt vmcnt(12)
    v_mfma_f32_16x16x32_bf16 v[8:11], v[116:119], v[80:83], v[8:11]
    v_mfma_f32_16x16x32_bf16 v[12:15], v[116:119], v[84:87], v[12:15]
    buffer_load_dwordx4 v[116:119], v137, s[8:11], s43 offen offset:256 sc1
    s_waitcnt vmcnt(12)
    v_mfma_f32_16x16x32_bf16 v[24:27], v[120:123], v[80:83], v[24:27]
    v_mfma_f32_16x16x32_bf16 v[28:31], v[120:123], v[84:87], v[28:31]
    buffer_load_dwordx4 v[120:123], v137, s[8:11], s43 offen offset:1280 sc1
    s_waitcnt vmcnt(12)
    v_mfma_f32_16x16x32_bf16 v[40:43], v[124:127], v[80:83], v[40:43]
    v_mfma_f32_16x16x32_bf16 v[44:47], v[124:127], v[84:87], v[44:47]
    buffer_load_dwordx4 v[124:127], v137, s[8:11], s43 offen offset:2304 sc1
    s_waitcnt vmcnt(12)
    v_mfma_f32_16x16x32_bf16 v[56:59], v[128:131], v[80:83], v[56:59]
    v_mfma_f32_16x16x32_bf16 v[60:63], v[128:131], v[84:87], v[60:63]
    buffer_load_dwordx4 v[128:131], v137, s[8:11], s43 offen offset:3328 sc1
    s_waitcnt vmcnt(12)
    v_mfma_f32_16x16x32_bf16 v[72:75], v[132:135], v[80:83], v[72:75]
    v_mfma_f32_16x16x32_bf16 v[76:79], v[132:135], v[84:87], v[76:79]
    buffer_load_dwordx4 v[132:135], v136, s[8:11], s43 offen offset:256 sc1
    s_add_u32 s43, s43, 40960
    s_waitcnt vmcnt(9)
    v_mfma_f32_16x16x32_bf16 v[0:3], v[96:99], v[88:91], v[0:3]
    v_mfma_f32_16x16x32_bf16 v[4:7], v[96:99], v[92:95], v[4:7]
    s_waitcnt vmcnt(8)
    v_mfma_f32_16x16x32_bf16 v[16:19], v[100:103], v[88:91], v[16:19]
    v_mfma_f32_16x16x32_bf16 v[20:23], v[100:103], v[92:95], v[20:23]
    s_waitcnt vmcnt(7)
    v_mfma_f32_16x16x32_bf16 v[32:35], v[104:107], v[88:91], v[32:35]
    v_mfma_f32_16x16x32_bf16 v[36:39], v[104:107], v[92:95], v[36:39]
    s_waitcnt vmcnt(6)
    v_mfma_f32_16x16x32_bf16 v[48:51], v[108:111], v[88:91], v[48:51]
    v_mfma_f32_16x16x32_bf16 v[52:55], v[108:111], v[92:95], v[52:55]
    s_waitcnt vmcnt(5)
    v_mfma_f32_16x16x32_bf16 v[64:67], v[112:115], v[88:91], v[64:67]
    v_mfma_f32_16x16x32_bf16 v[68:71], v[112:115], v[92:95], v[68:71]
    s_waitcnt vmcnt(4)
    v_mfma_f32_16x16x32_bf16 v[8:11], v[116:119], v[88:91], v[8:11]
    v_mfma_f32_16x16x32_bf16 v[12:15], v[116:119], v[92:95], v[12:15]
    s_waitcnt vmcnt(3)
    v_mfma_f32_16x16x32_bf16 v[24:27], v[120:123], v[88:91], v[24:27]
    v_mfma_f32_16x16x32_bf16 v[28:31], v[120:123], v[92:95], v[28:31]
    s_waitcnt vmcnt(2)
    v_mfma_f32_16x16x32_bf16 v[40:43], v[124:127], v[88:91], v[40:43]
    v_mfma_f32_16x16x32_bf16 v[44:47], v[124:127], v[92:95], v[44:47]
    s_waitcnt vmcnt(1)
    v_mfma_f32_16x16x32_bf16 v[56:59], v[128:131], v[88:91], v[56:59]
    v_mfma_f32_16x16x32_bf16 v[60:63], v[128:131], v[92:95], v[60:63]
    s_waitcnt vmcnt(0)
    v_mfma_f32_16x16x32_bf16 v[72:75], v[132:135], v[88:91], v[72:75]
    v_mfma_f32_16x16x32_bf16 v[76:79], v[132:135], v[92:95], v[76:79]
    s_mul_i32 s32, s54, 5
    s_add_u32 s33, s32, s25
    s_lshl_b32 s33, s33, 10
    s_add_u32 s44, s33, 16121856
    v_and_b32 v80, 15, v158
    v_mul_u32_u24 v80, 656, v80
    v_lshrrev_b32 v81, 4, v158
    v_lshl_add_u32 v80, v81, 4, v80
    s_mul_i32 s32, s25, 20992
    v_add_u32 v80, s32, v80
    s_waitcnt vmcnt(0)
.pollc28:
    v_xor_b32 v139, s31, v139
    v_cmp_ne_u32 vcc, 0, v139
    s_nop 0
    s_cmp_lg_u64 vcc, 0
    s_cbranch_scc1 .poll27
.polld29:
    s_barrier
    s_setprio 0
    buffer_load_dwordx4 v161, s[8:11], s45 offen sc1 lds
    s_add_u32 m0, m0, 4096
    s_add_u32 s45, s45, 4096
    buffer_load_dwordx4 v161, s[8:11], s45 offen sc1 lds
    s_add_u32 m0, m0, 4096
    s_add_u32 s45, s45, 4096
    buffer_load_dwordx4 v161, s[8:11], s45 offen sc1 lds
    s_add_u32 m0, m0, 4096
    s_add_u32 s45, s45, 4096
    buffer_load_dwordx4 v161, s[8:11], s45 offen sc1 lds
    s_add_u32 m0, m0, 4096
    s_add_u32 s45, s45, 4096
    ds_write_b128 v80, v[0:3] offset:0
    s_waitcnt lgkmcnt(0)
    ds_write_b128 v80, v[4:7] offset:10496
    s_waitcnt lgkmcnt(0)
    ds_write_b128 v80, v[8:11] offset:64
    s_waitcnt lgkmcnt(0)
    ds_write_b128 v80, v[12:15] offset:10560
    s_waitcnt lgkmcnt(0)
    ds_write_b128 v80, v[16:19] offset:128
    s_waitcnt lgkmcnt(0)
    ds_write_b128 v80, v[20:23] offset:10624
    s_waitcnt lgkmcnt(0)
    ds_write_b128 v80, v[24:27] offset:192
    s_waitcnt lgkmcnt(0)
    ds_write_b128 v80, v[28:31] offset:10688
    s_waitcnt lgkmcnt(0)
    s_waitcnt vmcnt(0)
    s_lshl_b32 s32, s25, 2
    s_add_u32 s32, s32, 112768
    v_mov_b32 v142, s32
    v_mov_b32 v143, s31
    ds_write_b32 v142, v143
    ds_write_b128 v80, v[32:35] offset:256
    s_waitcnt lgkmcnt(0)
    ds_write_b128 v80, v[36:39] offset:10752
    s_waitcnt lgkmcnt(0)
    ds_write_b128 v80, v[40:43] offset:320
    s_waitcnt lgkmcnt(0)
    ds_write_b128 v80, v[44:47] offset:10816
    s_waitcnt lgkmcnt(0)
    ds_write_b128 v80, v[48:51] offset:384
    s_waitcnt lgkmcnt(0)
    ds_write_b128 v80, v[52:55] offset:10880
    s_waitcnt lgkmcnt(0)
    ds_write_b128 v80, v[56:59] offset:448
    s_waitcnt lgkmcnt(0)
    ds_write_b128 v80, v[60:63] offset:10944
    s_waitcnt lgkmcnt(0)
    ds_write_b128 v80, v[64:67] offset:512
    s_waitcnt lgkmcnt(0)
    ds_write_b128 v80, v[68:71] offset:11008
    s_waitcnt lgkmcnt(0)
    ds_write_b128 v80, v[72:75] offset:576
    s_waitcnt lgkmcnt(0)
    ds_write_b128 v80, v[76:79] offset:11072
    s_waitcnt lgkmcnt(0)
    buffer_load_dwordx4 v[64:67], v161, s[8:11], s44 offen sc1
    s_add_u32 s44, s44, 20480
    buffer_load_dwordx4 v[68:71], v161, s[8:11], s44 offen sc1
    s_add_u32 s44, s44, 20480
    buffer_load_dwordx4 v[72:75], v161, s[8:11], s44 offen sc1
    s_add_u32 s44, s44, 20480
    buffer_load_dwordx4 v[76:79], v161, s[8:11], s44 offen sc1
    s_add_u32 s44, s44, 20480
    buffer_load_dwordx4 v[80:83], v161, s[8:11], s44 offen sc1
    s_add_u32 s44, s44, 20480
    buffer_load_dwordx4 v[84:87], v161, s[8:11], s44 offen sc1
    s_add_u32 s44, s44, 20480
    buffer_load_dwordx4 v[88:91], v161, s[8:11], s44 offen sc1
    s_add_u32 s44, s44, 20480
    buffer_load_dwordx4 v[92:95], v161, s[8:11], s44 offen sc1
    s_add_u32 s44, s44, 20480
    buffer_load_dwordx4 v[144:147], v161, s[8:11], s44 offen sc1
    s_add_u32 s44, s44, 20480
    buffer_load_dwordx4 v[162:165], v161, s[8:11], s44 offen sc1
    s_add_u32 s44, s44, 20480
    buffer_load_dwordx4 v[104:107], v161, s[8:11], s44 offen sc1
    s_add_u32 s44, s44, 20480
    buffer_load_dwordx4 v[108:111], v161, s[8:11], s44 offen sc1
    s_add_u32 s44, s44, 20480
    buffer_load_dwordx4 v[112:115], v161, s[8:11], s44 offen sc1
    s_add_u32 s44, s44, 20480
    buffer_load_dwordx4 v[116:119], v161, s[8:11], s44 offen sc1
    s_add_u32 s44, s44, 20480
    buffer_load_dwordx4 v[132:135], v161, s[8:11], s44 offen sc1
    s_add_u32 s44, s44, 20480
    buffer_load_dwordx4 v[0:3], v161, s[8:11], s44 offen sc1
    s_add_u32 s44, s44, 20480
    buffer_load_dwordx4 v[4:7], v161, s[8:11], s44 offen sc1
    s_add_u32 s44, s44, 20480
    buffer_load_dwordx4 v[8:11], v161, s[8:11], s44 offen sc1
    s_add_u32 s44, s44, 20480
    buffer_load_dwordx4 v[12:15], v161, s[8:11], s44 offen sc1
    s_add_u32 s44, s44, 20480
    buffer_load_dwordx4 v[16:19], v161, s[8:11], s44 offen sc1
    s_add_u32 s44, s44, 20480
    buffer_load_dwordx4 v[20:23], v161, s[8:11], s44 offen sc1
    s_add_u32 s44, s44, 20480
    buffer_load_dwordx4 v[24:27], v161, s[8:11], s44 offen sc1
    s_add_u32 s44, s44, 20480
    buffer_load_dwordx4 v[96:99], v161, s[8:11], s44 offen sc1
    s_add_u32 s44, s44, 20480
    buffer_load_dwordx4 v[100:103], v161, s[8:11], s44 offen sc1
    s_add_u32 s44, s44, 20480
    buffer_load_dwordx4 v[120:123], v161, s[8:11], s44 offen sc1
    s_setprio 0
    s_mov_b32 s12, s64
    s_mov_b32 s13, s65
    s_mov_b32 s14, 2621440
    s_mov_b32 s15, 0x20000
    s_mov_b32 s16, s78
    s_mov_b32 s17, s79
    s_mov_b32 s18, 1280
    s_mov_b32 s19, 0x20000
    s_lshl_b32 s32, s24, 6
    v_add_u32 v28, s32, v158
    v_mul_u32_u24 v29, 3277, v28
    v_lshrrev_b32 v29, 16, v29
    v_mul_u32_u24 v148, 20, v29
    v_sub_u32 v28, v28, v148
    v_mul_u32_u24 v148, 656, v29
    v_lshl_add_u32 v148, v28, 5, v148
    v_mul_u32_u24 v149, 1280, v29
    v_lshlrev_b32 v29, 4, v29
    s_lshl_b32 s34, s53, 9
    s_add_u32 s34, s34, 22237192
    buffer_load_dword v131, v29, s[8:11], s34 offen sc1
    v_lshlrev_b32 v29, 4, v28
    v_add_u32 v149, v149, v29
    v_cmp_le_u32 s[58:59], 16, v28
    s_mul_i32 s34, s54, 320
    s_mul_i32 s55, s53, 40960
    s_add_u32 s55, s55, s34
    buffer_load_dwordx4 v[150:153], v29, s[16:19], s34 offen
    buffer_load_dwordx4 v[154:157], v149, s[12:15], s55 offen
    s_mov_b32 s66, 0
    s_mov_b32 s67, 31
    s_mov_b32 s43, 0
    s_waitcnt vmcnt(0)
    s_xor_b32 s32, s24, 11
    s_or_b32 s32, s32, s2
    s_cbranch_scc1 .zero30
    v_lshlrev_b32 v28, 6, v158
    s_mov_b32 s32, 22546432
    s_mov_b32 s33, 22550528
    s_mov_b32 s34, 22554624
    s_mov_b32 s35, 22557696
    buffer_load_dword v30, v28, s[8:11], s32 offen sc1
    buffer_load_dword v31, v28, s[8:11], s33 offen sc1
    buffer_load_dword v32, v28, s[8:11], s34 offen sc1
    buffer_load_dword v33, v28, s[8:11], s35 offen sc1
    s_waitcnt vmcnt(0)
.pollc32:
    v_xor_b32 v30, s31, v30
    v_bitop3_b32 v30, v31, s31, v30 bitop3:0xbe
    v_bitop3_b32 v30, v32, s31, v30 bitop3:0xbe
    v_bitop3_b32 v30, v33, s31, v30 bitop3:0xbe
    v_cmp_ne_u32 vcc, 0, v30
    s_nop 0
    s_cmp_lg_u64 vcc, 0
    s_cbranch_scc1 .poll31
.polld33:
    s_mov_b32 s20, s82
    s_mov_b32 s21, s83
    s_mov_b32 s22, 256
    s_mov_b32 s23, 0x20000
    v_mov_b32 v28, 0
    s_mov_b64 exec, 1
    buffer_store_dword v28, v28, s[20:23], 0 offen sc1
    s_mov_b64 exec, -1
.zero30:
    s_barrier
    s_branch .gw10
.lonlya17:
    s_barrier
    s_waitcnt vmcnt(0)
    s_barrier
    s_barrier
    v_mov_b32 v10, 148992
    ds_read_b32 v10, v10
    s_waitcnt lgkmcnt(0)
    v_readfirstlane_b32 s31, v10
    s_branch .tr6
.ld3:
    s_waitcnt lgkmcnt(0)
    s_mov_b32 s8, s84
    s_mov_b32 s9, s85
    s_mov_b32 s10, 22837248
    s_mov_b32 s11, 0x20000
    s_cmp_ge_u32 s24, 4
    s_cbranch_scc1 .g22
    s_mov_b32 s41, 0
    s_cmp_ge_u32 s89, 240
    s_cbranch_scc1 .g1s34
    s_lshr_b32 s42, s25, 1
    s_and_b32 s43, s25, 1
    v_and_b32 v4, 15, v158
    v_lshrrev_b32 v5, 4, v158
    s_lshl_b32 s32, s42, 6
    v_add_u32 v1, s32, v4
    v_lshrrev_b32 v2, 1, v4
    v_xor_b32 v2, v2, v5
    v_lshlrev_b32 v2, 4, v2
    v_lshl_add_u32 v2, v1, 7, v2
    v_add_u32 v162, 65536, v2
    v_xor_b32 v163, 64, v162
    v_lshlrev_b32 v2, 11, v5
    v_bfe_u32 v3, v158, 2, 2
    v_lshl_add_u32 v2, v3, 6, v2
    v_and_b32 v3, 1, v5
    v_lshl_add_u32 v2, v3, 5, v2
    v_and_b32 v3, 3, v158
    v_lshl_add_u32 v2, v3, 3, v2
    s_lshl_b32 s33, s43, 9
    s_add_u32 s33, s33, 98304
    v_add_u32 v164, s33, v2
    v_xor_b32 v165, 32, v164
    v_lshlrev_b32 v2, 3, v1
    v_add_u32 v152, 147456, v2
    v_lshlrev_b32 v2, 2, v1
    v_add_u32 v154, 148480, v2
    s_lshl_b32 s33, s43, 9
    s_add_u32 s33, s33, 149504
    v_lshlrev_b32 v2, 3, v4
    v_add_u32 v153, s33, v2
    v_lshlrev_b32 v2, 4, v4
    v_lshl_add_u32 v148, v5, 9, v2
    v_mov_b32 v156, 148992
    v_mov_b32 v132, 0
    v_mov_b32 v133, 0
    v_mov_b32 v134, 0
    v_mov_b32 v135, 0
    v_mov_b32 v136, 0
    v_mov_b32 v137, 0
    v_mov_b32 v138, 0
    v_mov_b32 v139, 0
    v_mov_b32 v140, 0
    v_mov_b32 v141, 0
    v_mov_b32 v142, 0
    v_mov_b32 v143, 0
    v_mov_b32 v144, 0
    v_mov_b32 v145, 0
    v_mov_b32 v146, 0
    v_mov_b32 v147, 0
    s_mov_b32 s38, 0
    s_mov_b32 s44, 16384
    s_mov_b32 s60, 612517924
    s_mov_b32 s61, 584
    s_bitcmp1_b32 s60, 0
    s_cselect_b32 s39, 4294885376, s44
    s_bitcmp1_b32 s60, 1
    s_cselect_b32 s40, 4294934528, s44
    s_lshr_b64 s[60:61], s[60:61], 2
    s_lshl_b32 s5, s29, 1
    s_add_u32 s5, s5, s43
    s_cmp_ge_u32 s29, 10
    s_cbranch_scc1 .pv40
    s_cmp_lt_u32 s29, 5
    s_mov_b32 s32, 10240
    s_cmov_b32 s32, 5120
    s_cselect_b32 s34, 5242880, 0
    s_cselect_b32 s4, 1051011932, 1.0
    s_cselect_b32 s36, 0, 10
    s_cselect_b32 s37, 0, 8
    s_mov_b32 s6, 128
    s_cmov_b32 s6, 256
    s_sub_u32 s35, s5, s36
    s_lshl_b32 s35, s35, 4
    s_mul_i32 s36, s28, s32
    s_add_u32 s34, s34, s36
    s_lshl_b32 s36, s42, 11
    s_add_u32 s34, s34, s36
    s_lshl_b32 s33, s32, 4
    s_sub_u32 s33, s33, 2560
    s_mul_i32 s7, s42, 1536
    s_sub_u32 s7, 2048, s7
    v_and_b32 v1, s37, v4
    v_add_u32 v1, v1, v4
    v_lshlrev_b32 v1, 4, v1
    v_add_u32 v1, s34, v1
    v_add_u32 v5, s35, v5
    v_mul_u32_u24 v2, 13108, v5
    v_lshrrev_b32 v2, 16, v2
    v_mul_u32_u24 v3, 5, v2
    v_sub_u32 v3, v5, v3
    v_lshrrev_b32 v3, 2, v3
    v_mad_u32_u24 v3, v3, s7, v1
    v_lshl_add_u32 v3, v5, 9, v3
    v_mad_u32_u24 v148, v2, s33, v3
    v_add_u32 v5, 4, v5
    v_mul_u32_u24 v2, 13108, v5
    v_lshrrev_b32 v2, 16, v2
    v_mul_u32_u24 v3, 5, v2
    v_sub_u32 v3, v5, v3
    v_lshrrev_b32 v3, 2, v3
    v_mad_u32_u24 v3, v3, s7, v1
    v_lshl_add_u32 v3, v5, 9, v3
    v_mad_u32_u24 v149, v2, s33, v3
    v_add_u32 v5, 4, v5
    v_mul_u32_u24 v2, 13108, v5
    v_lshrrev_b32 v2, 16, v2
    v_mul_u32_u24 v3, 5, v2
    v_sub_u32 v3, v5, v3
    v_lshrrev_b32 v3, 2, v3
    v_mad_u32_u24 v3, v3, s7, v1
    v_lshl_add_u32 v3, v5, 9, v3
    v_mad_u32_u24 v150, v2, s33, v3
    v_add_u32 v5, 4, v5
    v_mul_u32_u24 v2, 13108, v5
    v_lshrrev_b32 v2, 16, v2
    v_mul_u32_u24 v3, 5, v2
    v_sub_u32 v3, v5, v3
    v_lshrrev_b32 v3, 2, v3
    v_mad_u32_u24 v3, v3, s7, v1
    v_lshl_add_u32 v3, v5, 9, v3
    v_mad_u32_u24 v151, v2, s33, v3
    v_add_u32 v5, 4, v5
    s_branch .pd41
.pv40:
    s_lshl_b32 s32, s42, 8
    s_add_u32 s32, s32, 148480
    v_lshlrev_b32 v154, 4, v5
    v_add_u32 v154, s32, v154
    s_mul_i32 s34, s28, 10240
    s_mul_i32 s33, s42, 2560
    s_add_u32 s34, s34, s33
    s_add_u32 s34, s34, 5120
    s_sub_u32 s33, s5, 20
    s_lshl_b32 s33, s33, 6
    s_mov_b32 s35, 163520
    v_mul_u32_u24 v1, 320, v5
    v_add_u32 v1, s34, v1
    v_add_u32 v4, s33, v4
    v_mul_u32_u24 v2, 3277, v4
    v_lshrrev_b32 v2, 16, v2
    v_lshl_add_u32 v3, v4, 4, v1
    v_mad_u32_u24 v148, v2, s35, v3
    v_add_u32 v4, 16, v4
    v_mul_u32_u24 v2, 3277, v4
    v_lshrrev_b32 v2, 16, v2
    v_lshl_add_u32 v3, v4, 4, v1
    v_mad_u32_u24 v149, v2, s35, v3
    v_add_u32 v4, 16, v4
    v_mul_u32_u24 v2, 3277, v4
    v_lshrrev_b32 v2, 16, v2
    v_lshl_add_u32 v3, v4, 4, v1
    v_mad_u32_u24 v150, v2, s35, v3
    v_add_u32 v4, 16, v4
    v_mul_u32_u24 v2, 3277, v4
    v_lshrrev_b32 v2, 16, v2
    v_lshl_add_u32 v3, v4, 4, v1
    v_mad_u32_u24 v151, v2, s35, v3
    v_add_u32 v4, 16, v4
.pd41:
    v_pk_mov_b32 v[0:1], v[134:135], v[134:135]
    v_pk_mov_b32 v[2:3], v[134:135], v[134:135]
    v_pk_mov_b32 v[4:5], v[134:135], v[134:135]
    v_pk_mov_b32 v[6:7], v[134:135], v[134:135]
    v_pk_mov_b32 v[8:9], v[134:135], v[134:135]
    v_pk_mov_b32 v[10:11], v[134:135], v[134:135]
    v_pk_mov_b32 v[12:13], v[134:135], v[134:135]
    v_pk_mov_b32 v[14:15], v[134:135], v[134:135]
    v_pk_mov_b32 v[16:17], v[134:135], v[134:135]
    v_pk_mov_b32 v[18:19], v[134:135], v[134:135]
    v_pk_mov_b32 v[20:21], v[134:135], v[134:135]
    v_pk_mov_b32 v[22:23], v[134:135], v[134:135]
    v_pk_mov_b32 v[24:25], v[134:135], v[134:135]
    v_pk_mov_b32 v[26:27], v[134:135], v[134:135]
    v_pk_mov_b32 v[28:29], v[134:135], v[134:135]
    v_pk_mov_b32 v[30:31], v[134:135], v[134:135]
    v_pk_mov_b32 v[32:33], v[134:135], v[134:135]
    v_pk_mov_b32 v[34:35], v[134:135], v[134:135]
    v_pk_mov_b32 v[36:37], v[134:135], v[134:135]
    v_pk_mov_b32 v[38:39], v[134:135], v[134:135]
    v_pk_mov_b32 v[40:41], v[134:135], v[134:135]
    v_pk_mov_b32 v[42:43], v[134:135], v[134:135]
    v_pk_mov_b32 v[44:45], v[134:135], v[134:135]
    v_pk_mov_b32 v[46:47], v[134:135], v[134:135]
    v_pk_mov_b32 v[48:49], v[134:135], v[134:135]
    v_pk_mov_b32 v[50:51], v[134:135], v[134:135]
    v_pk_mov_b32 v[52:53], v[134:135], v[134:135]
    v_pk_mov_b32 v[54:55], v[134:135], v[134:135]
    v_pk_mov_b32 v[56:57], v[134:135], v[134:135]
    v_pk_mov_b32 v[58:59], v[134:135], v[134:135]
    v_pk_mov_b32 v[60:61], v[134:135], v[134:135]
    v_pk_mov_b32 v[62:63], v[134:135], v[134:135]
    s_barrier
    ds_read_b64_tr_b16 v[80:81], v164 offset:0
    ds_read_b64_tr_b16 v[82:83], v164 offset:1024
    ds_read_b128 v[64:67], v162 offset:0
    ds_read_b128 v[68:71], v162 offset:2048
    ds_read_b128 v[72:75], v162 offset:4096
    ds_read_b128 v[76:79], v162 offset:6144
    ds_read_b64_tr_b16 v[84:85], v165 offset:0
    ds_read_b64_tr_b16 v[86:87], v165 offset:1024
    ds_read_b64_tr_b16 v[88:89], v164 offset:256
    ds_read_b64_tr_b16 v[90:91], v164 offset:1280
    ds_read_b64_tr_b16 v[92:93], v165 offset:256
    ds_read_b64_tr_b16 v[94:95], v165 offset:1280
    s_cmp_ge_u32 s29, 10
    s_cbranch_scc1 .lpV36
.p2align 3
.lpT35:
    s_waitcnt lgkmcnt(6)
    v_mfma_f32_16x16x32_bf16 v[0:3], v[80:83], v[64:67], v[0:3]
    ds_read_b64_tr_b16 v[112:113], v164 offset:8192
    v_mfma_f32_16x16x32_bf16 v[4:7], v[80:83], v[68:71], v[4:7]
    ds_read_b64_tr_b16 v[114:115], v164 offset:9216
    v_add_u32 v162, s39, v162
    v_mfma_f32_16x16x32_bf16 v[8:11], v[80:83], v[72:75], v[8:11]
    ds_read_b128 v[96:99], v163 offset:0
    v_mfma_f32_16x16x32_bf16 v[12:15], v[80:83], v[76:79], v[12:15]
    ds_read_b128 v[100:103], v163 offset:2048
    s_waitcnt lgkmcnt(8)
    v_mfma_f32_16x16x32_bf16 v[16:19], v[84:87], v[64:67], v[16:19]
    ds_read_b128 v[104:107], v163 offset:4096
    v_mfma_f32_16x16x32_bf16 v[20:23], v[84:87], v[68:71], v[20:23]
    ds_read_b128 v[108:111], v163 offset:6144
    v_mfma_f32_16x16x32_bf16 v[24:27], v[84:87], v[72:75], v[24:27]
    ds_read_b64_tr_b16 v[116:117], v165 offset:8192
    v_mfma_f32_16x16x32_bf16 v[28:31], v[84:87], v[76:79], v[28:31]
    ds_read_b64_tr_b16 v[118:119], v165 offset:9216
    s_waitcnt lgkmcnt(10)
    v_mfma_f32_16x16x32_bf16 v[32:35], v[88:91], v[64:67], v[32:35]
    ds_read_b64_tr_b16 v[120:121], v164 offset:8448
    v_mfma_f32_16x16x32_bf16 v[36:39], v[88:91], v[68:71], v[36:39]
    ds_read_b64_tr_b16 v[122:123], v164 offset:9472
    v_add_u32 v163, s39, v163
    v_mfma_f32_16x16x32_bf16 v[40:43], v[88:91], v[72:75], v[40:43]
    ds_read_b64_tr_b16 v[124:125], v165 offset:8448
    v_mfma_f32_16x16x32_bf16 v[44:47], v[88:91], v[76:79], v[44:47]
    ds_read_b64_tr_b16 v[126:127], v165 offset:9472
    s_waitcnt lgkmcnt(12)
    v_mfma_f32_16x16x32_bf16 v[48:51], v[92:95], v[64:67], v[48:51]
    v_add_u32 v164, s40, v164
    v_add_u32 v165, s40, v165
    v_mfma_f32_16x16x32_bf16 v[52:55], v[92:95], v[68:71], v[52:55]
    s_bitcmp1_b32 s60, 0
    s_cselect_b32 s39, 4294885376, s44
    v_mfma_f32_16x16x32_bf16 v[56:59], v[92:95], v[72:75], v[56:59]
    s_bitcmp1_b32 s60, 1
    s_cselect_b32 s40, 4294934528, s44
    v_mfma_f32_16x16x32_bf16 v[60:63], v[92:95], v[76:79], v[60:63]
.k142:
    s_waitcnt lgkmcnt(6)
    v_mfma_f32_16x16x32_bf16 v[0:3], v[112:115], v[96:99], v[0:3]
    s_lshr_b64 s[60:61], s[60:61], 2
    s_add_u32 s38, s38, 1
    v_mfma_f32_16x16x32_bf16 v[4:7], v[112:115], v[100:103], v[4:7]
    s_cmp_eq_u32 s38, 10
    v_mfma_f32_16x16x32_bf16 v[8:11], v[112:115], v[104:107], v[8:11]
    s_cbranch_scc1 .gl43
    v_mfma_f32_16x16x32_bf16 v[12:15], v[112:115], v[108:111], v[12:15]
    s_waitcnt lgkmcnt(0)
    s_barrier
    ds_read_b64_tr_b16 v[80:81], v164 offset:0
    v_mfma_f32_16x16x32_bf16 v[16:19], v[116:119], v[96:99], v[16:19]
    ds_read_b64_tr_b16 v[82:83], v164 offset:1024
    v_mfma_f32_16x16x32_bf16 v[20:23], v[116:119], v[100:103], v[20:23]
    ds_read_b128 v[64:67], v162 offset:0
    v_mfma_f32_16x16x32_bf16 v[24:27], v[116:119], v[104:107], v[24:27]
    ds_read_b128 v[68:71], v162 offset:2048
    v_mfma_f32_16x16x32_bf16 v[28:31], v[116:119], v[108:111], v[28:31]
    ds_read_b128 v[72:75], v162 offset:4096
    v_mfma_f32_16x16x32_bf16 v[32:35], v[120:123], v[96:99], v[32:35]
    ds_read_b128 v[76:79], v162 offset:6144
    v_mfma_f32_16x16x32_bf16 v[36:39], v[120:123], v[100:103], v[36:39]
    ds_read_b64_tr_b16 v[84:85], v165 offset:0
    v_mfma_f32_16x16x32_bf16 v[40:43], v[120:123], v[104:107], v[40:43]
    ds_read_b64_tr_b16 v[86:87], v165 offset:1024
    v_mfma_f32_16x16x32_bf16 v[44:47], v[120:123], v[108:111], v[44:47]
    ds_read_b64_tr_b16 v[88:89], v164 offset:256
    v_mfma_f32_16x16x32_bf16 v[48:51], v[124:127], v[96:99], v[48:51]
    ds_read_b64_tr_b16 v[90:91], v164 offset:1280
    v_mfma_f32_16x16x32_bf16 v[52:55], v[124:127], v[100:103], v[52:55]
    ds_read_b64_tr_b16 v[92:93], v165 offset:256
    v_mfma_f32_16x16x32_bf16 v[56:59], v[124:127], v[104:107], v[56:59]
    ds_read_b64_tr_b16 v[94:95], v165 offset:1280
    v_mfma_f32_16x16x32_bf16 v[60:63], v[124:127], v[108:111], v[60:63]
    s_branch .lpT35
.gl43:
    v_mfma_f32_16x16x32_bf16 v[12:15], v[112:115], v[108:111], v[12:15]
    s_waitcnt lgkmcnt(0)
    s_cmp_lg_u32 s41, 0
    s_cbranch_scc1 .gn44
    s_barrier
.gn44:
    s_mov_b64 exec, 0xffff
    ds_read_b64 v[132:133], v152 offset:0
    ds_read_b64 v[136:137], v152 offset:128
    ds_read_b64 v[140:141], v152 offset:256
    ds_read_b64 v[144:145], v152 offset:384
    s_mov_b64 exec, -1
    v_mfma_f32_16x16x32_bf16 v[16:19], v[116:119], v[96:99], v[16:19]
    ds_read_b64 v[80:81], v153 offset:0
    v_mfma_f32_16x16x32_bf16 v[20:23], v[116:119], v[100:103], v[20:23]
    ds_read_b64 v[84:85], v153 offset:128
    v_mfma_f32_16x16x32_bf16 v[24:27], v[116:119], v[104:107], v[24:27]
    ds_read_b64 v[88:89], v153 offset:256
    v_mfma_f32_16x16x32_bf16 v[28:31], v[116:119], v[108:111], v[28:31]
    ds_read_b64 v[92:93], v153 offset:384
    v_mfma_f32_16x16x32_bf16 v[32:35], v[120:123], v[96:99], v[32:35]
    ds_read_b32 v128, v154 offset:0
    v_mfma_f32_16x16x32_bf16 v[36:39], v[120:123], v[100:103], v[36:39]
    ds_read_b32 v129, v154 offset:64
    v_mfma_f32_16x16x32_bf16 v[40:43], v[120:123], v[104:107], v[40:43]
    ds_read_b32 v130, v154 offset:128
    v_mfma_f32_16x16x32_bf16 v[44:47], v[120:123], v[108:111], v[44:47]
    ds_read_b32 v131, v154 offset:192
    v_mfma_f32_16x16x32_bf16 v[48:51], v[124:127], v[96:99], v[48:51]
    ds_read_b32 v156, v156
    v_mfma_f32_16x16x32_bf16 v[52:55], v[124:127], v[100:103], v[52:55]
    v_mfma_f32_16x16x32_bf16 v[56:59], v[124:127], v[104:107], v[56:59]
    v_mfma_f32_16x16x32_bf16 v[60:63], v[124:127], v[108:111], v[60:63]
    s_waitcnt lgkmcnt(5)
    v_mfma_f32_16x16x32_bf16 v[0:3], v[80:83], v[132:135], v[0:3]
    v_mfma_f32_16x16x32_bf16 v[4:7], v[80:83], v[136:139], v[4:7]
    v_mfma_f32_16x16x32_bf16 v[8:11], v[80:83], v[140:143], v[8:11]
    v_mfma_f32_16x16x32_bf16 v[12:15], v[80:83], v[144:147], v[12:15]
    v_mfma_f32_16x16x32_bf16 v[16:19], v[84:87], v[132:135], v[16:19]
    v_mfma_f32_16x16x32_bf16 v[20:23], v[84:87], v[136:139], v[20:23]
    v_mfma_f32_16x16x32_bf16 v[24:27], v[84:87], v[140:143], v[24:27]
    v_mfma_f32_16x16x32_bf16 v[28:31], v[84:87], v[144:147], v[28:31]
    v_mfma_f32_16x16x32_bf16 v[32:35], v[88:91], v[132:135], v[32:35]
    v_mfma_f32_16x16x32_bf16 v[36:39], v[88:91], v[136:139], v[36:39]
    v_mfma_f32_16x16x32_bf16 v[40:43], v[88:91], v[140:143], v[40:43]
    v_mfma_f32_16x16x32_bf16 v[44:47], v[88:91], v[144:147], v[44:47]
    v_mfma_f32_16x16x32_bf16 v[48:51], v[92:95], v[132:135], v[48:51]
    v_mfma_f32_16x16x32_bf16 v[52:55], v[92:95], v[136:139], v[52:55]
    v_mfma_f32_16x16x32_bf16 v[56:59], v[92:95], v[140:143], v[56:59]
    v_mfma_f32_16x16x32_bf16 v[60:63], v[92:95], v[144:147], v[60:63]
    s_waitcnt lgkmcnt(0)
    s_cmp_lg_u32 s41, 0
    s_cbranch_scc1 .eh37
    v_mul_f32 v128, s4, v128
    v_mul_f32 v129, s4, v129
    v_mul_f32 v130, s4, v130
    v_mul_f32 v131, s4, v131
    v_mul_f32 v0, v128, v0
    v_mul_f32 v1, v128, v1
    v_mul_f32 v2, v128, v2
    v_mul_f32 v3, v128, v3
    v_mul_f32 v8, v130, v8
    v_mul_f32 v9, v130, v9
    v_mul_f32 v10, v130, v10
    v_mul_f32 v11, v130, v11
    v_cvt_pk_bf16_f32 v96, v0, v1
    v_cvt_pk_bf16_f32 v97, v2, v3
    v_cvt_pk_bf16_f32 v98, v8, v9
    v_cvt_pk_bf16_f32 v99, v10, v11
    buffer_store_dwordx4 v[96:99], v148, s[8:11], 0 offen sc1
    v_mul_f32 v4, v129, v4
    v_mul_f32 v5, v129, v5
    v_mul_f32 v6, v129, v6
    v_mul_f32 v7, v129, v7
    v_mul_f32 v12, v131, v12
    v_mul_f32 v13, v131, v13
    v_mul_f32 v14, v131, v14
    v_mul_f32 v15, v131, v15
    v_cvt_pk_bf16_f32 v100, v4, v5
    v_cvt_pk_bf16_f32 v101, v6, v7
    v_cvt_pk_bf16_f32 v102, v12, v13
    v_cvt_pk_bf16_f32 v103, v14, v15
    buffer_store_dwordx4 v[100:103], v148, s[8:11], s6 offen sc1
    v_mul_f32 v16, v128, v16
    v_mul_f32 v17, v128, v17
    v_mul_f32 v18, v128, v18
    v_mul_f32 v19, v128, v19
    v_mul_f32 v24, v130, v24
    v_mul_f32 v25, v130, v25
    v_mul_f32 v26, v130, v26
    v_mul_f32 v27, v130, v27
    v_cvt_pk_bf16_f32 v104, v16, v17
    v_cvt_pk_bf16_f32 v105, v18, v19
    v_cvt_pk_bf16_f32 v106, v24, v25
    v_cvt_pk_bf16_f32 v107, v26, v27
    buffer_store_dwordx4 v[104:107], v149, s[8:11], 0 offen sc1
    s_cmp_ge_u32 s89, 192
    s_cbranch_scc1 .me45
    s_barrier
.me45:
    v_mul_f32 v20, v129, v20
    v_mul_f32 v21, v129, v21
    v_mul_f32 v22, v129, v22
    v_mul_f32 v23, v129, v23
    v_mul_f32 v28, v131, v28
    v_mul_f32 v29, v131, v29
    v_mul_f32 v30, v131, v30
    v_mul_f32 v31, v131, v31
    v_cvt_pk_bf16_f32 v108, v20, v21
    v_cvt_pk_bf16_f32 v109, v22, v23
    v_cvt_pk_bf16_f32 v110, v28, v29
    v_cvt_pk_bf16_f32 v111, v30, v31
    buffer_store_dwordx4 v[108:111], v149, s[8:11], s6 offen sc1
    v_mul_f32 v32, v128, v32
    v_mul_f32 v33, v128, v33
    v_mul_f32 v34, v128, v34
    v_mul_f32 v35, v128, v35
    v_mul_f32 v40, v130, v40
    v_mul_f32 v41, v130, v41
    v_mul_f32 v42, v130, v42
    v_mul_f32 v43, v130, v43
    v_cvt_pk_bf16_f32 v112, v32, v33
    v_cvt_pk_bf16_f32 v113, v34, v35
    v_cvt_pk_bf16_f32 v114, v40, v41
    v_cvt_pk_bf16_f32 v115, v42, v43
    buffer_store_dwordx4 v[112:115], v150, s[8:11], 0 offen sc1
    v_mul_f32 v36, v129, v36
    v_mul_f32 v37, v129, v37
    v_mul_f32 v38, v129, v38
    v_mul_f32 v39, v129, v39
    v_mul_f32 v44, v131, v44
    v_mul_f32 v45, v131, v45
    v_mul_f32 v46, v131, v46
    v_mul_f32 v47, v131, v47
    v_cvt_pk_bf16_f32 v116, v36, v37
    v_cvt_pk_bf16_f32 v117, v38, v39
    v_cvt_pk_bf16_f32 v118, v44, v45
    v_cvt_pk_bf16_f32 v119, v46, v47
    buffer_store_dwordx4 v[116:119], v150, s[8:11], s6 offen sc1
    v_mul_f32 v48, v128, v48
    v_mul_f32 v49, v128, v49
    v_mul_f32 v50, v128, v50
    v_mul_f32 v51, v128, v51
    v_mul_f32 v56, v130, v56
    v_mul_f32 v57, v130, v57
    v_mul_f32 v58, v130, v58
    v_mul_f32 v59, v130, v59
    v_cvt_pk_bf16_f32 v120, v48, v49
    v_cvt_pk_bf16_f32 v121, v50, v51
    v_cvt_pk_bf16_f32 v122, v56, v57
    v_cvt_pk_bf16_f32 v123, v58, v59
    buffer_store_dwordx4 v[120:123], v151, s[8:11], 0 offen sc1
    v_mul_f32 v52, v129, v52
    v_mul_f32 v53, v129, v53
    v_mul_f32 v54, v129, v54
    v_mul_f32 v55, v129, v55
    v_mul_f32 v60, v131, v60
    v_mul_f32 v61, v131, v61
    v_mul_f32 v62, v131, v62
    v_mul_f32 v63, v131, v63
    v_cvt_pk_bf16_f32 v124, v52, v53
    v_cvt_pk_bf16_f32 v125, v54, v55
    v_cvt_pk_bf16_f32 v126, v60, v61
    v_cvt_pk_bf16_f32 v127, v62, v63
    buffer_store_dwordx4 v[124:127], v151, s[8:11], s6 offen sc1
.dA38:
    v_readfirstlane_b32 s31, v156
    s_cmp_ge_u32 s89, 192
    s_cbranch_scc1 .noB46
    s_branch .helpb15
.p2align 3
.lpV36:
    s_waitcnt lgkmcnt(6)
    v_mfma_f32_16x16x32_bf16 v[0:3], v[64:67], v[80:83], v[0:3]
    ds_read_b64_tr_b16 v[112:113], v164 offset:8192
    v_mfma_f32_16x16x32_bf16 v[4:7], v[68:71], v[80:83], v[4:7]
    ds_read_b64_tr_b16 v[114:115], v164 offset:9216
    v_add_u32 v162, s39, v162
    v_mfma_f32_16x16x32_bf16 v[8:11], v[72:75], v[80:83], v[8:11]
    ds_read_b128 v[96:99], v163 offset:0
    v_mfma_f32_16x16x32_bf16 v[12:15], v[76:79], v[80:83], v[12:15]
    ds_read_b128 v[100:103], v163 offset:2048
    s_waitcnt lgkmcnt(8)
    v_mfma_f32_16x16x32_bf16 v[16:19], v[64:67], v[84:87], v[16:19]
    ds_read_b128 v[104:107], v163 offset:4096
    v_mfma_f32_16x16x32_bf16 v[20:23], v[68:71], v[84:87], v[20:23]
    ds_read_b128 v[108:111], v163 offset:6144
    v_mfma_f32_16x16x32_bf16 v[24:27], v[72:75], v[84:87], v[24:27]
    ds_read_b64_tr_b16 v[116:117], v165 offset:8192
    v_mfma_f32_16x16x32_bf16 v[28:31], v[76:79], v[84:87], v[28:31]
    ds_read_b64_tr_b16 v[118:119], v165 offset:9216
    s_waitcnt lgkmcnt(10)
    v_mfma_f32_16x16x32_bf16 v[32:35], v[64:67], v[88:91], v[32:35]
    ds_read_b64_tr_b16 v[120:121], v164 offset:8448
    v_mfma_f32_16x16x32_bf16 v[36:39], v[68:71], v[88:91], v[36:39]
    ds_read_b64_tr_b16 v[122:123], v164 offset:9472
    v_add_u32 v163, s39, v163
    v_mfma_f32_16x16x32_bf16 v[40:43], v[72:75], v[88:91], v[40:43]
    ds_read_b64_tr_b16 v[124:125], v165 offset:8448
    v_mfma_f32_16x16x32_bf16 v[44:47], v[76:79], v[88:91], v[44:47]
    ds_read_b64_tr_b16 v[126:127], v165 offset:9472
    s_waitcnt lgkmcnt(12)
    v_mfma_f32_16x16x32_bf16 v[48:51], v[64:67], v[92:95], v[48:51]
    v_add_u32 v164, s40, v164
    v_add_u32 v165, s40, v165
    v_mfma_f32_16x16x32_bf16 v[52:55], v[68:71], v[92:95], v[52:55]
    s_bitcmp1_b32 s60, 0
    s_cselect_b32 s39, 4294885376, s44
    v_mfma_f32_16x16x32_bf16 v[56:59], v[72:75], v[92:95], v[56:59]
    s_bitcmp1_b32 s60, 1
    s_cselect_b32 s40, 4294934528, s44
    v_mfma_f32_16x16x32_bf16 v[60:63], v[76:79], v[92:95], v[60:63]
    s_waitcnt lgkmcnt(6)
    v_mfma_f32_16x16x32_bf16 v[0:3], v[96:99], v[112:115], v[0:3]
    s_lshr_b64 s[60:61], s[60:61], 2
    s_add_u32 s38, s38, 1
    v_mfma_f32_16x16x32_bf16 v[4:7], v[100:103], v[112:115], v[4:7]
    s_cmp_eq_u32 s38, 10
    v_mfma_f32_16x16x32_bf16 v[8:11], v[104:107], v[112:115], v[8:11]
    s_cbranch_scc1 .gl47
    v_mfma_f32_16x16x32_bf16 v[12:15], v[108:111], v[112:115], v[12:15]
    s_waitcnt lgkmcnt(0)
    s_barrier
    ds_read_b64_tr_b16 v[80:81], v164 offset:0
    v_mfma_f32_16x16x32_bf16 v[16:19], v[96:99], v[116:119], v[16:19]
    ds_read_b64_tr_b16 v[82:83], v164 offset:1024
    v_mfma_f32_16x16x32_bf16 v[20:23], v[100:103], v[116:119], v[20:23]
    ds_read_b128 v[64:67], v162 offset:0
    v_mfma_f32_16x16x32_bf16 v[24:27], v[104:107], v[116:119], v[24:27]
    ds_read_b128 v[68:71], v162 offset:2048
    v_mfma_f32_16x16x32_bf16 v[28:31], v[108:111], v[116:119], v[28:31]
    ds_read_b128 v[72:75], v162 offset:4096
    v_mfma_f32_16x16x32_bf16 v[32:35], v[96:99], v[120:123], v[32:35]
    ds_read_b128 v[76:79], v162 offset:6144
    v_mfma_f32_16x16x32_bf16 v[36:39], v[100:103], v[120:123], v[36:39]
    ds_read_b64_tr_b16 v[84:85], v165 offset:0
    v_mfma_f32_16x16x32_bf16 v[40:43], v[104:107], v[120:123], v[40:43]
    ds_read_b64_tr_b16 v[86:87], v165 offset:1024
    v_mfma_f32_16x16x32_bf16 v[44:47], v[108:111], v[120:123], v[44:47]
    ds_read_b64_tr_b16 v[88:89], v164 offset:256
    v_mfma_f32_16x16x32_bf16 v[48:51], v[96:99], v[124:127], v[48:51]
    ds_read_b64_tr_b16 v[90:91], v164 offset:1280
    v_mfma_f32_16x16x32_bf16 v[52:55], v[100:103], v[124:127], v[52:55]
    ds_read_b64_tr_b16 v[92:93], v165 offset:256
    v_mfma_f32_16x16x32_bf16 v[56:59], v[104:107], v[124:127], v[56:59]
    ds_read_b64_tr_b16 v[94:95], v165 offset:1280
    v_mfma_f32_16x16x32_bf16 v[60:63], v[108:111], v[124:127], v[60:63]
    s_branch .lpV36
.gl47:
    v_mfma_f32_16x16x32_bf16 v[12:15], v[108:111], v[112:115], v[12:15]
    s_waitcnt lgkmcnt(0)
    s_barrier
.gn48:
    s_mov_b64 exec, 0xffff
    ds_read_b64 v[132:133], v152 offset:0
    ds_read_b64 v[136:137], v152 offset:128
    ds_read_b64 v[140:141], v152 offset:256
    ds_read_b64 v[144:145], v152 offset:384
    s_mov_b64 exec, -1
    v_mfma_f32_16x16x32_bf16 v[16:19], v[96:99], v[116:119], v[16:19]
    ds_read_b64 v[80:81], v153 offset:0
    v_mfma_f32_16x16x32_bf16 v[20:23], v[100:103], v[116:119], v[20:23]
    ds_read_b64 v[84:85], v153 offset:128
    v_mfma_f32_16x16x32_bf16 v[24:27], v[104:107], v[116:119], v[24:27]
    ds_read_b64 v[88:89], v153 offset:256
    v_mfma_f32_16x16x32_bf16 v[28:31], v[108:111], v[116:119], v[28:31]
    ds_read_b64 v[92:93], v153 offset:384
    v_mfma_f32_16x16x32_bf16 v[32:35], v[96:99], v[120:123], v[32:35]
    ds_read_b128 v[64:67], v154 offset:0
    v_mfma_f32_16x16x32_bf16 v[36:39], v[100:103], v[120:123], v[36:39]
    ds_read_b128 v[68:71], v154 offset:64
    v_mfma_f32_16x16x32_bf16 v[40:43], v[104:107], v[120:123], v[40:43]
    ds_read_b128 v[72:75], v154 offset:128
    v_mfma_f32_16x16x32_bf16 v[44:47], v[108:111], v[120:123], v[44:47]
    ds_read_b128 v[76:79], v154 offset:192
    v_mfma_f32_16x16x32_bf16 v[48:51], v[96:99], v[124:127], v[48:51]
    ds_read_b32 v156, v156
    v_mfma_f32_16x16x32_bf16 v[52:55], v[100:103], v[124:127], v[52:55]
    v_mfma_f32_16x16x32_bf16 v[56:59], v[104:107], v[124:127], v[56:59]
    v_mfma_f32_16x16x32_bf16 v[60:63], v[108:111], v[124:127], v[60:63]
    s_waitcnt lgkmcnt(5)
    v_mfma_f32_16x16x32_bf16 v[0:3], v[132:135], v[80:83], v[0:3]
    v_mfma_f32_16x16x32_bf16 v[4:7], v[136:139], v[80:83], v[4:7]
    v_mfma_f32_16x16x32_bf16 v[8:11], v[140:143], v[80:83], v[8:11]
    v_mfma_f32_16x16x32_bf16 v[12:15], v[144:147], v[80:83], v[12:15]
    v_mfma_f32_16x16x32_bf16 v[16:19], v[132:135], v[84:87], v[16:19]
    v_mfma_f32_16x16x32_bf16 v[20:23], v[136:139], v[84:87], v[20:23]
    v_mfma_f32_16x16x32_bf16 v[24:27], v[140:143], v[84:87], v[24:27]
    v_mfma_f32_16x16x32_bf16 v[28:31], v[144:147], v[84:87], v[28:31]
    v_mfma_f32_16x16x32_bf16 v[32:35], v[132:135], v[88:91], v[32:35]
    v_mfma_f32_16x16x32_bf16 v[36:39], v[136:139], v[88:91], v[36:39]
    v_mfma_f32_16x16x32_bf16 v[40:43], v[140:143], v[88:91], v[40:43]
    v_mfma_f32_16x16x32_bf16 v[44:47], v[144:147], v[88:91], v[44:47]
    v_mfma_f32_16x16x32_bf16 v[48:51], v[132:135], v[92:95], v[48:51]
    v_mfma_f32_16x16x32_bf16 v[52:55], v[136:139], v[92:95], v[52:55]
    v_mfma_f32_16x16x32_bf16 v[56:59], v[140:143], v[92:95], v[56:59]
    v_mfma_f32_16x16x32_bf16 v[60:63], v[144:147], v[92:95], v[60:63]
    s_waitcnt lgkmcnt(0)
    v_mul_f32 v0, v64, v0
    v_mul_f32 v1, v65, v1
    v_mul_f32 v2, v66, v2
    v_mul_f32 v3, v67, v3
    v_mul_f32 v4, v68, v4
    v_mul_f32 v5, v69, v5
    v_mul_f32 v6, v70, v6
    v_mul_f32 v7, v71, v7
    v_cvt_pk_bf16_f32 v96, v0, v1
    v_cvt_pk_bf16_f32 v97, v2, v3
    v_cvt_pk_bf16_f32 v98, v4, v5
    v_cvt_pk_bf16_f32 v99, v6, v7
    buffer_store_dwordx4 v[96:99], v148, s[8:11], 0 offen offset:0 sc1
    v_mul_f32 v8, v72, v8
    v_mul_f32 v9, v73, v9
    v_mul_f32 v10, v74, v10
    v_mul_f32 v11, v75, v11
    v_mul_f32 v12, v76, v12
    v_mul_f32 v13, v77, v13
    v_mul_f32 v14, v78, v14
    v_mul_f32 v15, v79, v15
    v_cvt_pk_bf16_f32 v100, v8, v9
    v_cvt_pk_bf16_f32 v101, v10, v11
    v_cvt_pk_bf16_f32 v102, v12, v13
    v_cvt_pk_bf16_f32 v103, v14, v15
    buffer_store_dwordx4 v[100:103], v148, s[8:11], 0 offen offset:1280 sc1
    v_mul_f32 v16, v64, v16
    v_mul_f32 v17, v65, v17
    v_mul_f32 v18, v66, v18
    v_mul_f32 v19, v67, v19
    v_mul_f32 v20, v68, v20
    v_mul_f32 v21, v69, v21
    v_mul_f32 v22, v70, v22
    v_mul_f32 v23, v71, v23
    v_cvt_pk_bf16_f32 v104, v16, v17
    v_cvt_pk_bf16_f32 v105, v18, v19
    v_cvt_pk_bf16_f32 v106, v20, v21
    v_cvt_pk_bf16_f32 v107, v22, v23
    buffer_store_dwordx4 v[104:107], v149, s[8:11], 0 offen offset:0 sc1
    s_cmp_ge_u32 s89, 192
    s_cbranch_scc1 .me49
    s_barrier
.me49:
    v_mul_f32 v24, v72, v24
    v_mul_f32 v25, v73, v25
    v_mul_f32 v26, v74, v26
    v_mul_f32 v27, v75, v27
    v_mul_f32 v28, v76, v28
    v_mul_f32 v29, v77, v29
    v_mul_f32 v30, v78, v30
    v_mul_f32 v31, v79, v31
    v_cvt_pk_bf16_f32 v108, v24, v25
    v_cvt_pk_bf16_f32 v109, v26, v27
    v_cvt_pk_bf16_f32 v110, v28, v29
    v_cvt_pk_bf16_f32 v111, v30, v31
    buffer_store_dwordx4 v[108:111], v149, s[8:11], 0 offen offset:1280 sc1
    v_mul_f32 v32, v64, v32
    v_mul_f32 v33, v65, v33
    v_mul_f32 v34, v66, v34
    v_mul_f32 v35, v67, v35
    v_mul_f32 v36, v68, v36
    v_mul_f32 v37, v69, v37
    v_mul_f32 v38, v70, v38
    v_mul_f32 v39, v71, v39
    v_cvt_pk_bf16_f32 v112, v32, v33
    v_cvt_pk_bf16_f32 v113, v34, v35
    v_cvt_pk_bf16_f32 v114, v36, v37
    v_cvt_pk_bf16_f32 v115, v38, v39
    buffer_store_dwordx4 v[112:115], v150, s[8:11], 0 offen offset:0 sc1
    v_mul_f32 v40, v72, v40
    v_mul_f32 v41, v73, v41
    v_mul_f32 v42, v74, v42
    v_mul_f32 v43, v75, v43
    v_mul_f32 v44, v76, v44
    v_mul_f32 v45, v77, v45
    v_mul_f32 v46, v78, v46
    v_mul_f32 v47, v79, v47
    v_cvt_pk_bf16_f32 v116, v40, v41
    v_cvt_pk_bf16_f32 v117, v42, v43
    v_cvt_pk_bf16_f32 v118, v44, v45
    v_cvt_pk_bf16_f32 v119, v46, v47
    buffer_store_dwordx4 v[116:119], v150, s[8:11], 0 offen offset:1280 sc1
    v_mul_f32 v48, v64, v48
    v_mul_f32 v49, v65, v49
    v_mul_f32 v50, v66, v50
    v_mul_f32 v51, v67, v51
    v_mul_f32 v52, v68, v52
    v_mul_f32 v53, v69, v53
    v_mul_f32 v54, v70, v54
    v_mul_f32 v55, v71, v55
    v_cvt_pk_bf16_f32 v120, v48, v49
    v_cvt_pk_bf16_f32 v121, v50, v51
    v_cvt_pk_bf16_f32 v122, v52, v53
    v_cvt_pk_bf16_f32 v123, v54, v55
    buffer_store_dwordx4 v[120:123], v151, s[8:11], 0 offen offset:0 sc1
    v_mul_f32 v56, v72, v56
    v_mul_f32 v57, v73, v57
    v_mul_f32 v58, v74, v58
    v_mul_f32 v59, v75, v59
    v_mul_f32 v60, v76, v60
    v_mul_f32 v61, v77, v61
    v_mul_f32 v62, v78, v62
    v_mul_f32 v63, v79, v63
    v_cvt_pk_bf16_f32 v124, v56, v57
    v_cvt_pk_bf16_f32 v125, v58, v59
    v_cvt_pk_bf16_f32 v126, v60, v61
    v_cvt_pk_bf16_f32 v127, v62, v63
    buffer_store_dwordx4 v[124:127], v151, s[8:11], 0 offen offset:1280 sc1
    s_branch .dA38
.noB46:
    s_waitcnt vmcnt(0)
    s_barrier
    s_barrier
    s_branch .g1q39
.g1s34:
    s_waitcnt vmcnt(0) lgkmcnt(0)
    s_barrier
    s_barrier
    v_mov_b32 v128, 148992
    ds_read_b32 v128, v128
    s_waitcnt lgkmcnt(0)
    v_readfirstlane_b32 s31, v128
.g1q39:
    s_lshl_b32 s50, s26, 2
    s_and_b32 s34, s27, 3
    s_add_u32 s50, s50, s34
    s_mul_i32 s51, s50, 163840
    s_lshr_b32 s53, s26, 1
    s_lshl_b32 s53, s53, 4
    s_and_b32 s34, s27, 15
    s_add_u32 s53, s53, s34
    s_and_b32 s54, s26, 1
    s_lshl_b32 s54, s54, 1
    s_lshr_b32 s34, s27, 4
    s_add_u32 s54, s54, s34
    s_lshr_b32 s34, s24, 2
    s_lshr_b32 s52, s27, 2
    s_lshl_b32 s52, s52, 2
    s_add_u32 s52, s52, s25
    s_lshl_b32 s52, s52, 1
    s_add_u32 s52, s52, s34
    s_mul_i32 s63, s52, 40
    s_lshr_b32 s34, s50, 2
    s_add_u32 s62, s63, s34
    s_add_u32 s62, s62, s50
    s_lshl_b32 s62, s62, 10
    s_add_u32 s62, s62, 16941056
    s_mul_i32 s34, s34, 5
    s_add_u32 s63, s63, s34
    s_lshl_b32 s63, s63, 10
    s_and_b32 s34, s50, 3
    s_lshl_b32 s34, s34, 8
    s_add_u32 s63, s63, s34
    s_add_u32 s63, s63, 16945152
    s_lshr_b32 s71, s52, 1
    s_lshl_b32 s71, s71, 5
    s_add_u32 s71, s71, s50
    s_lshl_b32 s71, s71, 6
    s_add_u32 s71, s71, 22706176
    s_lshl_b32 s66, s25, 1
    s_cmp_lt_u32 s24, 4
    s_cmov_b32 s66, 5
    s_cselect_b32 s67, 7, 3
    s_cselect_b32 s34, s25, 4
    s_mul_i32 s70, s66, 100
    s_add_u32 s70, s70, s34
    s_mul_i32 s34, s54, 5
    s_add_u32 s70, s70, s34
    s_lshl_b32 s70, s70, 10
    s_add_u32 s70, s70, 16121856
    s_lshl_b32 s3, s53, 3
    s_add_u32 s3, s3, s24
    s_mul_i32 s3, s3, 5120
    s_add_u32 s3, s3, 16941056
    s_barrier
    s_branch .attn4
.eh37:
    s_barrier
    s_setprio 3
    s_lshl_b32 s32, s28, 1
    s_add_u32 s32, s32, s42
    s_sub_u32 s33, s30, 15
    s_lshl_b32 s33, s33, 1
    s_add_u32 s33, s33, s43
    s_lshl_b32 s46, s32, 5
    s_add_u32 s46, s46, s33
    s_lshl_b32 s46, s46, 6
    s_add_u32 s46, s46, 22607872
    s_mul_i32 s44, s32, 196608
    s_lshl_b32 s33, s33, 12
    s_add_u32 s44, s44, s33
    s_add_u32 s44, s44, 7864320
    v_mul_f32 v0, v0, |v0|
    v_mul_f32 v1, v1, |v1|
    v_mul_f32 v2, v2, |v2|
    v_mul_f32 v3, v3, |v3|
    v_mul_f32 v16, v16, |v16|
    v_mul_f32 v17, v17, |v17|
    v_mul_f32 v18, v18, |v18|
    v_mul_f32 v19, v19, |v19|
    v_cvt_pk_bf16_f32 v96, v0, v1
    v_cvt_pk_bf16_f32 v97, v2, v3
    v_cvt_pk_bf16_f32 v98, v16, v17
    v_cvt_pk_bf16_f32 v99, v18, v19
    v_pk_max_i16 v96, v96, 0
    v_pk_max_i16 v97, v97, 0
    v_pk_max_i16 v98, v98, 0
    v_pk_max_i16 v99, v99, 0
    buffer_store_dwordx4 v[96:99], v148, s[8:11], s44 offen offset:0 sc1
    v_mul_f32 v32, v32, |v32|
    v_mul_f32 v33, v33, |v33|
    v_mul_f32 v34, v34, |v34|
    v_mul_f32 v35, v35, |v35|
    v_mul_f32 v48, v48, |v48|
    v_mul_f32 v49, v49, |v49|
    v_mul_f32 v50, v50, |v50|
    v_mul_f32 v51, v51, |v51|
    v_cvt_pk_bf16_f32 v100, v32, v33
    v_cvt_pk_bf16_f32 v101, v34, v35
    v_cvt_pk_bf16_f32 v102, v48, v49
    v_cvt_pk_bf16_f32 v103, v50, v51
    v_pk_max_i16 v100, v100, 0
    v_pk_max_i16 v101, v101, 0
    v_pk_max_i16 v102, v102, 0
    v_pk_max_i16 v103, v103, 0
    buffer_store_dwordx4 v[100:103], v148, s[8:11], s44 offen offset:2048 sc1
    v_mul_f32 v4, v4, |v4|
    v_mul_f32 v5, v5, |v5|
    v_mul_f32 v6, v6, |v6|
    v_mul_f32 v7, v7, |v7|
    v_mul_f32 v20, v20, |v20|
    v_mul_f32 v21, v21, |v21|
    v_mul_f32 v22, v22, |v22|
    v_mul_f32 v23, v23, |v23|
    v_cvt_pk_bf16_f32 v104, v4, v5
    v_cvt_pk_bf16_f32 v105, v6, v7
    v_cvt_pk_bf16_f32 v106, v20, v21
    v_cvt_pk_bf16_f32 v107, v22, v23
    v_pk_max_i16 v104, v104, 0
    v_pk_max_i16 v105, v105, 0
    v_pk_max_i16 v106, v106, 0
    v_pk_max_i16 v107, v107, 0
    buffer_store_dwordx4 v[104:107], v148, s[8:11], s44 offen offset:256 sc1
    v_mul_f32 v36, v36, |v36|
    v_mul_f32 v37, v37, |v37|
    v_mul_f32 v38, v38, |v38|
    v_mul_f32 v39, v39, |v39|
    v_mul_f32 v52, v52, |v52|
    v_mul_f32 v53, v53, |v53|
    v_mul_f32 v54, v54, |v54|
    v_mul_f32 v55, v55, |v55|
    v_cvt_pk_bf16_f32 v108, v36, v37
    v_cvt_pk_bf16_f32 v109, v38, v39
    v_cvt_pk_bf16_f32 v110, v52, v53
    v_cvt_pk_bf16_f32 v111, v54, v55
    v_pk_max_i16 v108, v108, 0
    v_pk_max_i16 v109, v109, 0
    v_pk_max_i16 v110, v110, 0
    v_pk_max_i16 v111, v111, 0
    buffer_store_dwordx4 v[108:111], v148, s[8:11], s44 offen offset:2304 sc1
    s_add_u32 s44, s44, 98304
    v_mul_f32 v8, v8, |v8|
    v_mul_f32 v9, v9, |v9|
    v_mul_f32 v10, v10, |v10|
    v_mul_f32 v11, v11, |v11|
    v_mul_f32 v24, v24, |v24|
    v_mul_f32 v25, v25, |v25|
    v_mul_f32 v26, v26, |v26|
    v_mul_f32 v27, v27, |v27|
    v_cvt_pk_bf16_f32 v112, v8, v9
    v_cvt_pk_bf16_f32 v113, v10, v11
    v_cvt_pk_bf16_f32 v114, v24, v25
    v_cvt_pk_bf16_f32 v115, v26, v27
    v_pk_max_i16 v112, v112, 0
    v_pk_max_i16 v113, v113, 0
    v_pk_max_i16 v114, v114, 0
    v_pk_max_i16 v115, v115, 0
    buffer_store_dwordx4 v[112:115], v148, s[8:11], s44 offen offset:0 sc1
    v_mul_f32 v40, v40, |v40|
    v_mul_f32 v41, v41, |v41|
    v_mul_f32 v42, v42, |v42|
    v_mul_f32 v43, v43, |v43|
    v_mul_f32 v56, v56, |v56|
    v_mul_f32 v57, v57, |v57|
    v_mul_f32 v58, v58, |v58|
    v_mul_f32 v59, v59, |v59|
    v_cvt_pk_bf16_f32 v116, v40, v41
    v_cvt_pk_bf16_f32 v117, v42, v43
    v_cvt_pk_bf16_f32 v118, v56, v57
    v_cvt_pk_bf16_f32 v119, v58, v59
    v_pk_max_i16 v116, v116, 0
    v_pk_max_i16 v117, v117, 0
    v_pk_max_i16 v118, v118, 0
    v_pk_max_i16 v119, v119, 0
    buffer_store_dwordx4 v[116:119], v148, s[8:11], s44 offen offset:2048 sc1
    v_mul_f32 v12, v12, |v12|
    v_mul_f32 v13, v13, |v13|
    v_mul_f32 v14, v14, |v14|
    v_mul_f32 v15, v15, |v15|
    v_mul_f32 v28, v28, |v28|
    v_mul_f32 v29, v29, |v29|
    v_mul_f32 v30, v30, |v30|
    v_mul_f32 v31, v31, |v31|
    v_cvt_pk_bf16_f32 v120, v12, v13
    v_cvt_pk_bf16_f32 v121, v14, v15
    v_cvt_pk_bf16_f32 v122, v28, v29
    v_cvt_pk_bf16_f32 v123, v30, v31
    v_pk_max_i16 v120, v120, 0
    v_pk_max_i16 v121, v121, 0
    v_pk_max_i16 v122, v122, 0
    v_pk_max_i16 v123, v123, 0
    buffer_store_dwordx4 v[120:123], v148, s[8:11], s44 offen offset:256 sc1
    v_mul_f32 v44, v44, |v44|
    v_mul_f32 v45, v45, |v45|
    v_mul_f32 v46, v46, |v46|
    v_mul_f32 v47, v47, |v47|
    v_mul_f32 v60, v60, |v60|
    v_mul_f32 v61, v61, |v61|
    v_mul_f32 v62, v62, |v62|
    v_mul_f32 v63, v63, |v63|
    v_cvt_pk_bf16_f32 v124, v44, v45
    v_cvt_pk_bf16_f32 v125, v46, v47
    v_cvt_pk_bf16_f32 v126, v60, v61
    v_cvt_pk_bf16_f32 v127, v62, v63
    v_pk_max_i16 v124, v124, 0
    v_pk_max_i16 v125, v125, 0
    v_pk_max_i16 v126, v126, 0
    v_pk_max_i16 v127, v127, 0
    buffer_store_dwordx4 v[124:127], v148, s[8:11], s44 offen offset:2304 sc1
    s_branch .attn4
.g22:
    s_cmp_ge_u32 s89, 240
    s_cbranch_scc1 .stat13
    s_lshl_b32 s32, s25, 5
    v_add_u32 v9, s32, v159
    v_lshlrev_b32 v19, 3, v9
    v_add_u32 v12, 149504, v19
    v_mul_u32_u24 v2, 5120, v160
    v_add_u32 v19, v19, v2
    v_add_u32 v13, 153600, v19
    s_getpc_b64 s[4:5]
.an53:
    s_add_u32 s4, s4, .sub52-.an53
    s_addc_u32 s5, s5, 0
    v_lshlrev_b32 v2, 11, v160
    v_bfe_u32 v3, v158, 2, 2
    v_lshl_add_u32 v2, v3, 6, v2
    v_bfe_u32 v3, v158, 4, 1
    v_xor_b32 v3, v3, v160
    v_lshl_add_u32 v2, v3, 5, v2
    v_and_b32 v3, 3, v158
    v_lshl_add_u32 v2, v3, 3, v2
    s_lshl_b32 s33, s25, 8
    s_add_u32 s33, s33, 98304
    v_add_u32 v14, s33, v2
    v_mov_b32 v15, 0x3f803f80
    v_lshlrev_b32 v18, 4, v9
    v_lshlrev_b32 v10, 3, v9
    v_lshl_add_u32 v17, v160, 30, v10
    v_add_u32 v10, 147456, v10
    v_lshlrev_b32 v11, 2, v9
    v_add_u32 v11, 148480, v11
    v_add_u32 v16, 151552, v18
    v_mov_b32 v27, 0
    s_lshl_b32 s45, s28, 11
    s_add_u32 s45, s45, 22237184
    s_barrier
    ds_read_b64_tr_b16 v[32:33], v14 offset:0
    ds_read_b64_tr_b16 v[34:35], v14 offset:1024
    ds_read_b64_tr_b16 v[36:37], v14 offset:4096
    ds_read_b64_tr_b16 v[38:39], v14 offset:5120
    ds_read_b64_tr_b16 v[40:41], v14 offset:8192
    ds_read_b64_tr_b16 v[42:43], v14 offset:9216
    ds_read_b64_tr_b16 v[44:45], v14 offset:12288
    ds_read_b64_tr_b16 v[46:47], v14 offset:13312
    s_add_u32 s33, s57, 0
    s_cmp_ge_u32 s33, 10
    s_cselect_b32 s32, 10, 0
    s_sub_u32 s33, s33, s32
    s_mul_i32 s44, s29, 10
    s_add_u32 s33, s44, s33
    s_lshl_b32 s33, s33, 10
    s_add_u32 s33, s33, 22269952
    s_lshl_b32 s44, s44, 10
    s_add_u32 s44, s44, 22269952
    v_mov_b32 v24, 0
    v_mov_b32 v25, 0
    s_waitcnt lgkmcnt(0)
    s_load_dword s31, s[82:83], 0
    v_dot2c_f32_bf16 v24, v32, v15
    v_dot2c_f32_bf16 v25, v33, v15
    v_dot2c_f32_bf16 v24, v34, v15
    v_dot2c_f32_bf16 v25, v35, v15
    v_dot2c_f32_bf16 v24, v36, v15
    v_dot2c_f32_bf16 v25, v37, v15
    v_dot2c_f32_bf16 v24, v38, v15
    v_dot2c_f32_bf16 v25, v39, v15
    v_dot2c_f32_bf16 v24, v40, v15
    v_dot2c_f32_bf16 v25, v41, v15
    v_dot2c_f32_bf16 v24, v42, v15
    v_dot2c_f32_bf16 v25, v43, v15
    v_dot2c_f32_bf16 v24, v44, v15
    v_dot2c_f32_bf16 v25, v45, v15
    v_dot2c_f32_bf16 v24, v46, v15
    v_dot2c_f32_bf16 v25, v47, v15
    s_nop 2
    v_add_f32 v24, v24, v25
    v_mov_b32 v25, v24
    s_nop 1
    v_permlane32_swap_b32 v24, v25
    v_add_f32 v24, v24, v25
    s_barrier
    s_barrier
    s_setprio 3
    s_waitcnt lgkmcnt(0)
    s_cmp_lg_u32 s31, 0
    s_cbranch_scc1 .npd55
    s_mov_b32 s20, s82
    s_mov_b32 s21, s83
    s_mov_b32 s22, 256
    s_mov_b32 s23, 0x20000
    v_mov_b32 v3, 0
.np54:
    buffer_load_dword v2, v3, s[20:23], 0 offen sc1
    s_waitcnt vmcnt(0)
    v_readfirstlane_b32 s31, v2
    s_cmp_lg_u32 s31, 0
    s_cbranch_scc1 .npd55
    s_sleep 2
    s_sub_u32 s56, s56, 1
    s_cbranch_scc0 .np54
    s_mov_b32 s56, 0
.npd55:
    v_mov_b32 v3, 148992
    v_mov_b32 v2, s31
    ds_write_b32 v3, v2
    v_mov_b32 v25, s31
    buffer_store_dwordx2 v[24:25], v17, s[8:11], s33 offen sc1
    s_waitcnt lgkmcnt(0)
    s_barrier
    s_setprio 0
    s_lshl_b32 s50, s26, 2
    s_and_b32 s34, s27, 3
    s_add_u32 s50, s50, s34
    s_mul_i32 s51, s50, 163840
    s_lshr_b32 s53, s26, 1
    s_lshl_b32 s53, s53, 4
    s_and_b32 s34, s27, 15
    s_add_u32 s53, s53, s34
    s_and_b32 s54, s26, 1
    s_lshl_b32 s54, s54, 1
    s_lshr_b32 s34, s27, 4
    s_add_u32 s54, s54, s34
    s_lshr_b32 s34, s24, 2
    s_lshr_b32 s52, s27, 2
    s_lshl_b32 s52, s52, 2
    s_add_u32 s52, s52, s25
    s_lshl_b32 s52, s52, 1
    s_add_u32 s52, s52, s34
    s_mul_i32 s63, s52, 40
    s_lshr_b32 s34, s50, 2
    s_add_u32 s62, s63, s34
    s_add_u32 s62, s62, s50
    s_lshl_b32 s62, s62, 10
    s_add_u32 s62, s62, 16941056
    s_mul_i32 s34, s34, 5
    s_add_u32 s63, s63, s34
    s_lshl_b32 s63, s63, 10
    s_and_b32 s34, s50, 3
    s_lshl_b32 s34, s34, 8
    s_add_u32 s63, s63, s34
    s_add_u32 s63, s63, 16945152
    s_lshr_b32 s71, s52, 1
    s_lshl_b32 s71, s71, 5
    s_add_u32 s71, s71, s50
    s_lshl_b32 s71, s71, 6
    s_add_u32 s71, s71, 22706176
    s_lshl_b32 s66, s25, 1
    s_cmp_lt_u32 s24, 4
    s_cmov_b32 s66, 5
    s_cselect_b32 s67, 7, 3
    s_cselect_b32 s34, s25, 4
    s_mul_i32 s70, s66, 100
    s_add_u32 s70, s70, s34
    s_mul_i32 s34, s54, 5
    s_add_u32 s70, s70, s34
    s_lshl_b32 s70, s70, 10
    s_add_u32 s70, s70, 16121856
    s_lshl_b32 s3, s53, 3
    s_add_u32 s3, s3, s24
    s_mul_i32 s3, s3, 5120
    s_add_u32 s3, s3, 16941056
    s_barrier
    s_lshr_b32 s42, s25, 1
    s_and_b32 s43, s25, 1
    v_and_b32 v4, 15, v158
    v_lshrrev_b32 v5, 4, v158
    s_lshl_b32 s32, s42, 6
    v_add_u32 v1, s32, v4
    v_lshrrev_b32 v2, 1, v4
    v_xor_b32 v2, v2, v5
    v_lshlrev_b32 v2, 4, v2
    v_lshl_add_u32 v2, v1, 7, v2
    v_add_u32 v162, 32768, v2
    v_xor_b32 v163, 64, v162
    v_lshlrev_b32 v2, 11, v5
    v_bfe_u32 v3, v158, 2, 2
    v_lshl_add_u32 v2, v3, 6, v2
    v_and_b32 v3, 1, v5
    v_lshl_add_u32 v2, v3, 5, v2
    v_and_b32 v3, 3, v158
    v_lshl_add_u32 v2, v3, 3, v2
    s_lshl_b32 s33, s43, 9
    s_add_u32 s33, s33, 114688
    v_add_u32 v164, s33, v2
    v_xor_b32 v165, 32, v164
    v_lshlrev_b32 v2, 3, v1
    v_add_u32 v152, 147456, v2
    v_lshlrev_b32 v2, 2, v1
    v_add_u32 v154, 148480, v2
    s_lshl_b32 s33, s43, 9
    s_add_u32 s33, s33, 149504
    v_lshlrev_b32 v2, 3, v4
    v_add_u32 v153, s33, v2
    v_lshlrev_b32 v2, 4, v4
    v_lshl_add_u32 v148, v5, 9, v2
    v_mov_b32 v156, 148992
    v_mov_b32 v132, 0
    v_mov_b32 v133, 0
    v_mov_b32 v134, 0
    v_mov_b32 v135, 0
    v_mov_b32 v136, 0
    v_mov_b32 v137, 0
    v_mov_b32 v138, 0
    v_mov_b32 v139, 0
    v_mov_b32 v140, 0
    v_mov_b32 v141, 0
    v_mov_b32 v142, 0
    v_mov_b32 v143, 0
    v_mov_b32 v144, 0
    v_mov_b32 v145, 0
    v_mov_b32 v146, 0
    v_mov_b32 v147, 0
    s_barrier
    s_barrier
    s_barrier
    s_barrier
    ds_read_b64 v[52:53], v13 offset:0
    ds_read_b64 v[54:55], v13 offset:1024
    ds_read_b64 v[56:57], v13 offset:2048
    ds_read_b64 v[58:59], v13 offset:3072
    ds_read_b64 v[60:61], v13 offset:4096
    s_swappc_b64 s[6:7], s[4:5]
    s_barrier
    ds_read_b128 v[32:35], v16
    s_waitcnt lgkmcnt(0)
.pollc57:
    v_xor_b32 v33, s31, v33
    v_bitop3_b32 v33, v35, s31, v33 bitop3:0xbe
    v_cmp_ne_u32 vcc, 0, v33
    s_nop 0
    s_cmp_lg_u64 vcc, 0
    s_cbranch_scc1 .poll56
.polld58:
    v_and_b32 v38, 0xffff0000, v34
    v_rcp_f32 v38, v38
    v_mov_b32 v33, v34
    ds_write_b64 v10, v[32:33]
    ds_write_b32 v11, v38
    s_waitcnt lgkmcnt(0)
    s_cmp_ge_u32 s89, 192
    s_cbranch_scc1 .g2tr50
    s_barrier
    ds_read_b64_tr_b16 v[32:33], v14 offset:16384
    ds_read_b64_tr_b16 v[34:35], v14 offset:17408
    ds_read_b64_tr_b16 v[36:37], v14 offset:20480
    ds_read_b64_tr_b16 v[38:39], v14 offset:21504
    ds_read_b64_tr_b16 v[40:41], v14 offset:24576
    ds_read_b64_tr_b16 v[42:43], v14 offset:25600
    ds_read_b64_tr_b16 v[44:45], v14 offset:28672
    ds_read_b64_tr_b16 v[46:47], v14 offset:29696
    s_add_u32 s33, s57, 4
    s_cmp_ge_u32 s33, 10
    s_cselect_b32 s32, 10, 0
    s_sub_u32 s33, s33, s32
    s_mul_i32 s44, s30, 10
    s_add_u32 s33, s44, s33
    s_lshl_b32 s33, s33, 10
    s_add_u32 s33, s33, 22269952
    s_lshl_b32 s44, s44, 10
    s_add_u32 s44, s44, 22269952
    v_mov_b32 v24, 0
    v_mov_b32 v25, 0
    s_waitcnt lgkmcnt(0)
    ds_read_b64_tr_b16 v[80:81], v164 offset:0
    ds_read_b64_tr_b16 v[82:83], v164 offset:1024
    ds_read_b128 v[64:67], v162 offset:0
    ds_read_b128 v[68:71], v162 offset:2048
    ds_read_b128 v[72:75], v162 offset:4096
    ds_read_b128 v[76:79], v162 offset:6144
    ds_read_b64_tr_b16 v[84:85], v165 offset:0
    ds_read_b64_tr_b16 v[86:87], v165 offset:1024
    ds_read_b64_tr_b16 v[88:89], v164 offset:256
    ds_read_b64_tr_b16 v[90:91], v164 offset:1280
    ds_read_b64_tr_b16 v[92:93], v165 offset:256
    ds_read_b64_tr_b16 v[94:95], v165 offset:1280
    v_dot2c_f32_bf16 v24, v32, v15
    v_dot2c_f32_bf16 v25, v33, v15
    v_dot2c_f32_bf16 v24, v34, v15
    v_dot2c_f32_bf16 v25, v35, v15
    v_dot2c_f32_bf16 v24, v36, v15
    v_dot2c_f32_bf16 v25, v37, v15
    v_dot2c_f32_bf16 v24, v38, v15
    v_dot2c_f32_bf16 v25, v39, v15
    v_dot2c_f32_bf16 v24, v40, v15
    v_dot2c_f32_bf16 v25, v41, v15
    v_dot2c_f32_bf16 v24, v42, v15
    v_dot2c_f32_bf16 v25, v43, v15
    v_dot2c_f32_bf16 v24, v44, v15
    v_dot2c_f32_bf16 v25, v45, v15
    v_dot2c_f32_bf16 v24, v46, v15
    v_dot2c_f32_bf16 v25, v47, v15
    s_nop 2
    v_add_f32 v24, v24, v25
    v_mov_b32 v25, v24
    s_nop 1
    v_permlane32_swap_b32 v24, v25
    v_add_f32 v24, v24, v25
    v_mov_b32 v25, s31
    buffer_store_dwordx2 v[24:25], v17, s[8:11], s33 offen sc1
    s_mov_b32 s38, 0
    s_mov_b32 s44, 16384
    s_mov_b32 s60, 2392648
    s_mov_b32 s61, 0
    s_bitcmp1_b32 s60, 0
    s_cselect_b32 s39, 4294885376, s44
    s_bitcmp1_b32 s60, 1
    s_cselect_b32 s40, 4294934528, s44
    s_lshr_b64 s[60:61], s[60:61], 2
    s_mov_b32 s41, 1
    s_waitcnt lgkmcnt(6)
    v_mfma_f32_16x16x32_bf16 v[0:3], v[80:83], v[64:67], 0
    ds_read_b64_tr_b16 v[112:113], v164 offset:8192
    v_mfma_f32_16x16x32_bf16 v[4:7], v[80:83], v[68:71], 0
    ds_read_b64_tr_b16 v[114:115], v164 offset:9216
    v_add_u32 v162, s39, v162
    v_mfma_f32_16x16x32_bf16 v[8:11], v[80:83], v[72:75], 0
    ds_read_b128 v[96:99], v163 offset:0
    v_mfma_f32_16x16x32_bf16 v[12:15], v[80:83], v[76:79], 0
    ds_read_b128 v[100:103], v163 offset:2048
    s_waitcnt lgkmcnt(8)
    v_mfma_f32_16x16x32_bf16 v[16:19], v[84:87], v[64:67], 0
    ds_read_b128 v[104:107], v163 offset:4096
    v_mfma_f32_16x16x32_bf16 v[20:23], v[84:87], v[68:71], 0
    ds_read_b128 v[108:111], v163 offset:6144
    v_mfma_f32_16x16x32_bf16 v[24:27], v[84:87], v[72:75], 0
    ds_read_b64_tr_b16 v[116:117], v165 offset:8192
    v_mfma_f32_16x16x32_bf16 v[28:31], v[84:87], v[76:79], 0
    ds_read_b64_tr_b16 v[118:119], v165 offset:9216
    s_waitcnt lgkmcnt(10)
    v_mfma_f32_16x16x32_bf16 v[32:35], v[88:91], v[64:67], 0
    ds_read_b64_tr_b16 v[120:121], v164 offset:8448
    v_mfma_f32_16x16x32_bf16 v[36:39], v[88:91], v[68:71], 0
    ds_read_b64_tr_b16 v[122:123], v164 offset:9472
    v_add_u32 v163, s39, v163
    v_mfma_f32_16x16x32_bf16 v[40:43], v[88:91], v[72:75], 0
    ds_read_b64_tr_b16 v[124:125], v165 offset:8448
    v_mfma_f32_16x16x32_bf16 v[44:47], v[88:91], v[76:79], 0
    ds_read_b64_tr_b16 v[126:127], v165 offset:9472
    s_waitcnt lgkmcnt(12)
    v_mfma_f32_16x16x32_bf16 v[48:51], v[92:95], v[64:67], 0
    v_add_u32 v164, s40, v164
    v_add_u32 v165, s40, v165
    v_mfma_f32_16x16x32_bf16 v[52:55], v[92:95], v[68:71], 0
    s_bitcmp1_b32 s60, 0
    s_cselect_b32 s39, 4294885376, s44
    v_mfma_f32_16x16x32_bf16 v[56:59], v[92:95], v[72:75], 0
    s_bitcmp1_b32 s60, 1
    s_cselect_b32 s40, 4294934528, s44
    v_mfma_f32_16x16x32_bf16 v[60:63], v[92:95], v[76:79], 0
    s_branch .k142
.helpb15:
    s_mov_b32 s16, s74
    s_mov_b32 s17, s75
    s_mov_b32 s18, 3072
    s_mov_b32 s19, 0x20000
    s_sub_u32 s32, s30, 15
    s_lshl_b32 s32, s32, 8
    s_lshl_b32 s33, s25, 6
    s_add_u32 s32, s32, s33
    v_lshlrev_b32 v2, 1, v159
    buffer_load_ushort v27, v2, s[16:19], s32 offen
    s_barrier
    s_lshl_b32 s32, s25, 5
    v_add_u32 v9, s32, v159
    v_lshlrev_b32 v19, 3, v9
    v_add_u32 v12, 149504, v19
    v_mul_u32_u24 v2, 5120, v160
    v_add_u32 v19, v19, v2
    v_add_u32 v13, 153600, v19
    s_getpc_b64 s[4:5]
.an59:
    s_add_u32 s4, s4, .sub52-.an59
    s_addc_u32 s5, s5, 0
    s_mul_i32 s44, s30, 10240
    s_add_u32 s44, s44, 22269952
    s_lshl_b32 s50, s26, 2
    s_and_b32 s34, s27, 3
    s_add_u32 s50, s50, s34
    s_mul_i32 s51, s50, 163840
    s_lshr_b32 s53, s26, 1
    s_lshl_b32 s53, s53, 4
    s_and_b32 s34, s27, 15
    s_add_u32 s53, s53, s34
    s_and_b32 s54, s26, 1
    s_lshl_b32 s54, s54, 1
    s_lshr_b32 s34, s27, 4
    s_add_u32 s54, s54, s34
    s_mul_i32 s45, s50, 20
    s_add_u32 s33, s45, 19
    s_lshr_b32 s45, s45, 7
    s_lshr_b32 s33, s33, 7
    s_sub_u32 s33, s33, s45
    s_lshl_b32 s33, s33, 10
    v_bfe_u32 v2, v158, 4, 1
    v_mul_lo_u32 v2, v2, s33
    v_and_b32 v3, 15, v158
    v_lshl_add_u32 v28, v3, 6, v2
    v_mul_u32_u24 v3, 5120, v160
    v_add_u32 v28, v28, v3
    v_and_b32 v3, 1, v158
    v_lshl_add_u32 v31, v3, 6, v2
    s_lshl_b32 s45, s45, 10
    s_add_u32 s45, s45, 22546432
    s_lshr_b32 s46, s27, 2
    s_lshl_b32 s46, s46, 7
    s_add_u32 s46, s46, s45
    s_add_u32 s45, s45, 5120
    s_waitcnt vmcnt(0)
    s_barrier
    s_cmp_lg_u32 s24, 0
    s_cbranch_scc1 .qf64
    s_lshl_b32 s32, s29, 4
    s_add_u32 s32, s32, s28
    s_lshl_b32 s32, s32, 6
    s_add_u32 s32, s32, 22546432
    v_mov_b32 v20, s31
    v_mov_b32 v21, 0
    s_mov_b64 exec, 1
    buffer_store_dword v20, v21, s[8:11], s32 offen sc1
    s_mov_b64 exec, -1
.qf64:
    s_lshr_b32 s34, s24, 2
    s_lshr_b32 s52, s27, 2
    s_lshl_b32 s52, s52, 2
    s_add_u32 s52, s52, s25
    s_lshl_b32 s52, s52, 1
    s_add_u32 s52, s52, s34
    s_mul_i32 s63, s52, 40
    s_lshr_b32 s34, s50, 2
    s_add_u32 s62, s63, s34
    s_add_u32 s62, s62, s50
    s_lshl_b32 s62, s62, 10
    s_add_u32 s62, s62, 16941056
    s_mul_i32 s34, s34, 5
    s_add_u32 s63, s63, s34
    s_lshl_b32 s63, s63, 10
    s_and_b32 s34, s50, 3
    s_lshl_b32 s34, s34, 8
    s_add_u32 s63, s63, s34
    s_add_u32 s63, s63, 16945152
    s_lshr_b32 s71, s52, 1
    s_lshl_b32 s71, s71, 5
    s_add_u32 s71, s71, s50
    s_lshl_b32 s71, s71, 6
    s_add_u32 s71, s71, 22706176
    s_lshl_b32 s66, s25, 1
    s_cmp_lt_u32 s24, 4
    s_cmov_b32 s66, 5
    s_cselect_b32 s67, 7, 3
    s_cselect_b32 s34, s25, 4
    s_mul_i32 s70, s66, 100
    s_add_u32 s70, s70, s34
    s_mul_i32 s34, s54, 5
    s_add_u32 s70, s70, s34
    s_lshl_b32 s70, s70, 10
    s_add_u32 s70, s70, 16121856
    s_lshl_b32 s3, s53, 3
    s_add_u32 s3, s3, s24
    s_mul_i32 s3, s3, 5120
    s_add_u32 s3, s3, 16941056
    s_barrier
    s_barrier
    s_barrier
    ds_read_b64 v[52:53], v13 offset:0
    ds_read_b64 v[54:55], v13 offset:1024
    ds_read_b64 v[56:57], v13 offset:2048
    ds_read_b64 v[58:59], v13 offset:3072
    ds_read_b64 v[60:61], v13 offset:4096
    buffer_load_dword v29, v28, s[8:11], s45 offen sc1
    buffer_load_dword v30, v31, s[8:11], s46 offen sc1
    s_swappc_b64 s[6:7], s[4:5]
    s_barrier
    s_waitcnt vmcnt(0)
    v_xor_b32 v29, s31, v29
    v_bitop3_b32 v29, v30, s31, v29 bitop3:0xbe
    v_cmp_ne_u32 vcc, 0, v29
    s_nop 0
    s_cmp_lg_u64 vcc, 0
    s_cbranch_scc1 .n1660
    s_lshl_b32 s34, s25, 10
    s_mov_b32 m0, s34
    s_add_u32 s35, s34, s51
    buffer_load_dwordx4 v161, s[8:11], s35 offen sc1 lds
    s_add_u32 m0, m0, 4096
    s_add_u32 s35, s35, 4096
    buffer_load_dwordx4 v161, s[8:11], s35 offen sc1 lds
    s_add_u32 m0, m0, 4096
    s_add_u32 s35, s35, 4096
    buffer_load_dwordx4 v161, s[8:11], s35 offen sc1 lds
    s_add_u32 m0, m0, 4096
    s_add_u32 s35, s35, 4096
    buffer_load_dwordx4 v161, s[8:11], s35 offen sc1 lds
    s_add_u32 m0, m0, 4096
    s_add_u32 s35, s35, 4096
    s_barrier
    buffer_load_dwordx4 v161, s[8:11], s35 offen sc1 lds
    s_add_u32 m0, s34, 153600
    s_lshr_b32 s35, s27, 2
    s_mul_i32 s35, s35, 10240
    s_mul_i32 s33, s50, 81920
    s_add_u32 s35, s35, s33
    s_add_u32 s35, s35, s34
    s_add_u32 s35, s35, 5242880
    buffer_load_dwordx4 v161, s[8:11], s35 offen sc1 lds
    s_add_u32 m0, m0, 4096
    s_add_u32 s35, s35, 4096
    buffer_load_dwordx4 v161, s[8:11], s35 offen sc1 lds
    s_and_b32 s33, s25, 2
    s_lshl_b32 s33, s33, 10
    s_sub_u32 s33, 4096, s33
    s_add_u32 m0, m0, s33
    s_add_u32 s35, s35, s33
    buffer_load_dwordx4 v161, s[8:11], s35 offen sc1 lds
    s_barrier
    s_branch .g2nb63
.n1660:
    buffer_load_dword v29, v28, s[8:11], s45 offen sc1
    buffer_load_dword v30, v31, s[8:11], s46 offen sc1
    s_barrier
    s_waitcnt vmcnt(0)
    v_xor_b32 v29, s31, v29
    v_bitop3_b32 v29, v30, s31, v29 bitop3:0xbe
    v_cmp_ne_u32 vcc, 0, v29
    s_nop 0
    s_cmp_lg_u64 vcc, 0
    s_cbranch_scc1 .n1761
    s_lshl_b32 s34, s25, 10
    s_mov_b32 m0, s34
    s_add_u32 s35, s34, s51
    buffer_load_dwordx4 v161, s[8:11], s35 offen sc1 lds
    s_add_u32 m0, m0, 4096
    s_add_u32 s35, s35, 4096
    buffer_load_dwordx4 v161, s[8:11], s35 offen sc1 lds
    s_add_u32 m0, m0, 4096
    s_add_u32 s35, s35, 4096
    buffer_load_dwordx4 v161, s[8:11], s35 offen sc1 lds
    s_add_u32 m0, m0, 4096
    s_add_u32 s35, s35, 4096
    buffer_load_dwordx4 v161, s[8:11], s35 offen sc1 lds
    s_add_u32 m0, m0, 4096
    s_add_u32 s35, s35, 4096
    s_barrier
    buffer_load_dwordx4 v161, s[8:11], s35 offen sc1 lds
    s_add_u32 m0, s34, 153600
    s_lshr_b32 s35, s27, 2
    s_mul_i32 s35, s35, 10240
    s_mul_i32 s33, s50, 81920
    s_add_u32 s35, s35, s33
    s_add_u32 s35, s35, s34
    s_add_u32 s35, s35, 5242880
    buffer_load_dwordx4 v161, s[8:11], s35 offen sc1 lds
    s_add_u32 m0, m0, 4096
    s_add_u32 s35, s35, 4096
    buffer_load_dwordx4 v161, s[8:11], s35 offen sc1 lds
    s_and_b32 s33, s25, 2
    s_lshl_b32 s33, s33, 10
    s_sub_u32 s33, 4096, s33
    s_add_u32 m0, m0, s33
    s_add_u32 s35, s35, s33
    buffer_load_dwordx4 v161, s[8:11], s35 offen sc1 lds
    s_branch .g2nb63
.n1761:
    buffer_load_dword v29, v28, s[8:11], s45 offen sc1
    buffer_load_dword v30, v31, s[8:11], s46 offen sc1
    s_barrier
    s_branch .g2late62
.sub52:
    s_waitcnt lgkmcnt(0)
.pollc66:
    v_xor_b32 v53, s31, v53
    v_bitop3_b32 v53, v55, s31, v53 bitop3:0xbe
    v_bitop3_b32 v53, v57, s31, v53 bitop3:0xbe
    v_bitop3_b32 v53, v59, s31, v53 bitop3:0xbe
    v_bitop3_b32 v53, v61, s31, v53 bitop3:0xbe
    v_cmp_ne_u32 vcc, 0, v53
    s_nop 0
    s_cmp_lg_u64 vcc, 0
    s_cbranch_scc1 .poll65
.polld67:
    v_add_f32 v52, v52, v54
    v_add_f32 v56, v56, v58
    v_add_f32 v52, v52, v60
    v_add_f32 v52, v52, v56
    v_mov_b32 v53, v52
    s_nop 1
    v_permlane32_swap_b32 v52, v53
    v_add_f32 v52, v52, v53
    v_cvt_pk_bf16_f32 v54, v52, v52
    v_and_b32 v55, 0xffff0000, v54
    v_sub_f32 v56, v52, v55
    v_cvt_pk_bf16_f32 v57, v56, v56
    v_and_b32 v57, 0xffff0000, v57
    v_sub_f32 v56, v56, v57
    v_cvt_pk_bf16_f32 v56, v56, v56
    v_lshrrev_b32 v54, 16, v54
    v_or_b32 v54, v54, v57
    v_lshrrev_b32 v56, 16, v56
    v_lshl_or_b32 v55, v27, 16, v56
    ds_write_b64 v12, v[54:55]
    s_waitcnt lgkmcnt(0)
    s_setpc_b64 s[6:7]
.g2tr50:
    s_barrier
    s_branch .tr6
.trg27:
    s_lshl_b32 s50, s26, 2
    s_and_b32 s34, s27, 3
    s_add_u32 s50, s50, s34
    s_mul_i32 s51, s50, 163840
    s_lshr_b32 s53, s26, 1
    s_lshl_b32 s53, s53, 4
    s_and_b32 s34, s27, 15
    s_add_u32 s53, s53, s34
    s_and_b32 s54, s26, 1
    s_lshl_b32 s54, s54, 1
    s_lshr_b32 s34, s27, 4
    s_add_u32 s54, s54, s34
    s_lshr_b32 s34, s24, 2
    s_lshr_b32 s52, s27, 2
    s_lshl_b32 s52, s52, 2
    s_add_u32 s52, s52, s25
    s_lshl_b32 s52, s52, 1
    s_add_u32 s52, s52, s34
    s_mul_i32 s63, s52, 40
    s_lshr_b32 s34, s50, 2
    s_add_u32 s62, s63, s34
    s_add_u32 s62, s62, s50
    s_lshl_b32 s62, s62, 10
    s_add_u32 s62, s62, 16941056
    s_mul_i32 s34, s34, 5
    s_add_u32 s63, s63, s34
    s_lshl_b32 s63, s63, 10
    s_and_b32 s34, s50, 3
    s_lshl_b32 s34, s34, 8
    s_add_u32 s63, s63, s34
    s_add_u32 s63, s63, 16945152
    s_lshr_b32 s71, s52, 1
    s_lshl_b32 s71, s71, 5
    s_add_u32 s71, s71, s50
    s_lshl_b32 s71, s71, 6
    s_add_u32 s71, s71, 22706176
    s_lshl_b32 s66, s25, 1
    s_cmp_lt_u32 s24, 4
    s_cmov_b32 s66, 5
    s_cselect_b32 s67, 7, 3
    s_cselect_b32 s34, s25, 4
    s_mul_i32 s70, s66, 100
    s_add_u32 s70, s70, s34
    s_mul_i32 s34, s54, 5
    s_add_u32 s70, s70, s34
    s_lshl_b32 s70, s70, 10
    s_add_u32 s70, s70, 16121856
    s_lshl_b32 s3, s53, 3
    s_add_u32 s3, s3, s24
    s_mul_i32 s3, s3, 5120
    s_add_u32 s3, s3, 16941056
    s_mul_i32 s45, s50, 20
    s_add_u32 s33, s45, 19
    s_lshr_b32 s45, s45, 7
    s_lshr_b32 s33, s33, 7
    s_sub_u32 s33, s33, s45
    s_lshl_b32 s33, s33, 10
    v_bfe_u32 v2, v158, 4, 1
    v_mul_lo_u32 v2, v2, s33
    v_and_b32 v3, 15, v158
    v_lshl_add_u32 v28, v3, 6, v2
    v_mul_u32_u24 v3, 5120, v160
    v_add_u32 v28, v28, v3
    v_and_b32 v3, 1, v158
    v_lshl_add_u32 v31, v3, 6, v2
    s_lshl_b32 s45, s45, 10
    s_add_u32 s45, s45, 22546432
    s_lshr_b32 s46, s27, 2
    s_lshl_b32 s46, s46, 7
    s_add_u32 s46, s46, s45
    s_add_u32 s45, s45, 5120
    buffer_load_dword v29, v28, s[8:11], s45 offen sc1
    buffer_load_dword v30, v31, s[8:11], s46 offen sc1
.g2late62:
    s_waitcnt vmcnt(0)
.pollc69:
    v_xor_b32 v29, s31, v29
    v_bitop3_b32 v29, v30, s31, v29 bitop3:0xbe
    v_cmp_ne_u32 vcc, 0, v29
    s_nop 0
    s_cmp_lg_u64 vcc, 0
    s_cbranch_scc1 .poll68
.polld70:
    s_lshl_b32 s34, s25, 10
    s_mov_b32 m0, s34
    s_add_u32 s35, s34, s51
    buffer_load_dwordx4 v161, s[8:11], s35 offen sc1 lds
    s_add_u32 m0, m0, 4096
    s_add_u32 s35, s35, 4096
    buffer_load_dwordx4 v161, s[8:11], s35 offen sc1 lds
    s_add_u32 m0, m0, 4096
    s_add_u32 s35, s35, 4096
    buffer_load_dwordx4 v161, s[8:11], s35 offen sc1 lds
    s_add_u32 m0, m0, 4096
    s_add_u32 s35, s35, 4096
    buffer_load_dwordx4 v161, s[8:11], s35 offen sc1 lds
    s_add_u32 m0, m0, 4096
    s_add_u32 s35, s35, 4096
    buffer_load_dwordx4 v161, s[8:11], s35 offen sc1 lds
    s_add_u32 m0, s34, 153600
    s_lshr_b32 s35, s27, 2
    s_mul_i32 s35, s35, 10240
    s_mul_i32 s33, s50, 81920
    s_add_u32 s35, s35, s33
    s_add_u32 s35, s35, s34
    s_add_u32 s35, s35, 5242880
    buffer_load_dwordx4 v161, s[8:11], s35 offen sc1 lds
    s_add_u32 m0, m0, 4096
    s_add_u32 s35, s35, 4096
    buffer_load_dwordx4 v161, s[8:11], s35 offen sc1 lds
    s_and_b32 s33, s25, 2
    s_lshl_b32 s33, s33, 10
    s_sub_u32 s33, 4096, s33
    s_add_u32 m0, m0, s33
    s_add_u32 s35, s35, s33
    buffer_load_dwordx4 v161, s[8:11], s35 offen sc1 lds
.g2nb63:
    s_mov_b32 s41, 2
    s_mov_b32 s47, 0
    s_mov_b32 s46, s71
    s_setprio 0
    v_mov_b32 v140, 0
    v_mov_b32 v141, 0
    v_mov_b32 v142, 0
    v_mov_b32 v143, 0
    v_mov_b32 v32, 0
    v_mov_b32 v33, 0
    v_mov_b32 v34, 0
    v_mov_b32 v35, 0
    v_mov_b32 v36, 0
    v_mov_b32 v37, 0
    v_mov_b32 v38, 0
    v_mov_b32 v39, 0
    v_mov_b32 v40, 0
    v_mov_b32 v41, 0
    v_mov_b32 v42, 0
    v_mov_b32 v43, 0
    v_mov_b32 v44, 0
    v_mov_b32 v45, 0
    v_mov_b32 v46, 0
    v_mov_b32 v47, 0
    v_mov_b32 v48, 0
    v_mov_b32 v49, 0
    v_mov_b32 v50, 0
    v_mov_b32 v51, 0
    v_mov_b32 v52, 0
    v_mov_b32 v53, 0
    v_mov_b32 v54, 0
    v_mov_b32 v55, 0
    v_mov_b32 v56, 0
    v_mov_b32 v57, 0
    v_mov_b32 v58, 0
    v_mov_b32 v59, 0
    v_mov_b32 v60, 0
    v_mov_b32 v61, 0
    v_mov_b32 v62, 0
    v_mov_b32 v63, 0
    v_mov_b32 v100, 0
    v_mov_b32 v101, 0
    v_mov_b32 v102, 0
    v_mov_b32 v103, 0
    v_mov_b32 v108, 0x3f803f80
    v_mov_b32 v109, 0
    v_mov_b32 v110, 0x3f803f80
    v_mov_b32 v111, 0
    v_and_b32 v112, 31, v159
    v_cmp_eq_u32 vcc, 24, v112
    s_nop 1
    v_cndmask_b32 v112, v109, v108, vcc
    v_mov_b32 v113, v112
    v_mov_b32 v114, v112
    v_mov_b32 v115, v112
    v_mov_b32 v116, v112
    v_mov_b32 v117, v112
    v_mov_b32 v118, v112
    v_mov_b32 v119, v112
    v_mov_b32 v120, v112
    v_mov_b32 v121, v112
    v_mov_b32 v122, v112
    v_mov_b32 v123, v112
    s_lshr_b32 s43, s24, 2
    s_mov_b32 s48, 0x000fffff
    s_mov_b32 s49, 0x000fffff
    s_mul_i32 s32, s43, 10240
    v_add_u32 v124, s32, v161
    v_add_u32 v130, 8, v124
    v_mul_u32_u24 v125, 320, v160
    v_lshl_add_u32 v125, v159, 4, v125
    v_add_u32 v125, s32, v125
    v_and_b32 v166, 3, v158
    v_lshlrev_b32 v166, 8, v166
    v_add_u32 v166, 4096, v166
    s_lshr_b32 s32, s25, 1
    s_mul_i32 s32, s32, 5120
    s_add_u32 s32, s32, 153600
    s_and_b32 s33, s25, 1
    s_lshl_b32 s33, s33, 11
    s_lshl_b32 s34, s43, 3
    s_add_u32 s33, s33, s34
    s_xor_b32 s34, s33, 8
    s_add_u32 s33, s33, s32
    s_add_u32 s34, s34, s32
    v_add_u32 v126, s33, v161
    v_add_u32 v127, s34, v161
    s_and_b32 s33, s25, 1
    s_lshl_b32 s33, s33, 9
    s_add_u32 s32, s32, s33
    s_add_u32 s32, s32, 4096
    s_lshl_b32 s33, s43, 3
    s_xor_b32 s34, s33, 8
    s_add_u32 s33, s33, s32
    s_add_u32 s34, s34, s32
    v_add_u32 v128, s33, v161
    v_add_u32 v129, s34, v161
    s_cmp_eq_u32 s43, 0
    s_cselect_b32 s45, 5, 6
    s_mov_b32 s42, 231
    s_cmov_b32 s42, 231
    s_waitcnt vmcnt(0)
    s_mov_b32 s12, s64
    s_mov_b32 s13, s65
    s_mov_b32 s14, 2621440
    s_mov_b32 s15, 0x20000
    s_mov_b32 s16, s78
    s_mov_b32 s17, s79
    s_mov_b32 s18, 1280
    s_mov_b32 s19, 0x20000
    s_lshl_b32 s32, s24, 6
    v_add_u32 v22, s32, v158
    v_mul_u32_u24 v23, 3277, v22
    v_lshrrev_b32 v23, 16, v23
    v_mul_u32_u24 v148, 20, v23
    v_sub_u32 v22, v22, v148
    v_mul_u32_u24 v148, 656, v23
    v_lshl_add_u32 v148, v22, 5, v148
    v_mul_u32_u24 v149, 1280, v23
    v_lshlrev_b32 v23, 4, v23
    s_lshl_b32 s34, s53, 9
    s_add_u32 s34, s34, 22237192
    buffer_load_dword v131, v23, s[8:11], s34 offen sc1
    v_lshlrev_b32 v23, 4, v22
    v_add_u32 v149, v149, v23
    v_cmp_le_u32 s[58:59], 16, v22
    s_mul_i32 s34, s54, 320
    s_mul_i32 s55, s53, 40960
    s_add_u32 s55, s55, s34
    buffer_load_dwordx4 v[150:153], v23, s[16:19], s34 offen
    buffer_load_dwordx4 v[154:157], v149, s[12:15], s55 offen
    s_barrier
    s_branch .attn212
.attn4:
    s_mov_b32 s47, 1
    v_mov_b32 v140, 0
    v_mov_b32 v141, 0
    v_mov_b32 v142, 0
    v_mov_b32 v143, 0
    v_mov_b32 v32, 0
    v_mov_b32 v33, 0
    v_mov_b32 v34, 0
    v_mov_b32 v35, 0
    v_mov_b32 v36, 0
    v_mov_b32 v37, 0
    v_mov_b32 v38, 0
    v_mov_b32 v39, 0
    v_mov_b32 v40, 0
    v_mov_b32 v41, 0
    v_mov_b32 v42, 0
    v_mov_b32 v43, 0
    v_mov_b32 v44, 0
    v_mov_b32 v45, 0
    v_mov_b32 v46, 0
    v_mov_b32 v47, 0
    v_mov_b32 v48, 0
    v_mov_b32 v49, 0
    v_mov_b32 v50, 0
    v_mov_b32 v51, 0
    v_mov_b32 v52, 0
    v_mov_b32 v53, 0
    v_mov_b32 v54, 0
    v_mov_b32 v55, 0
    v_mov_b32 v56, 0
    v_mov_b32 v57, 0
    v_mov_b32 v58, 0
    v_mov_b32 v59, 0
    v_mov_b32 v60, 0
    v_mov_b32 v61, 0
    v_mov_b32 v62, 0
    v_mov_b32 v63, 0
    v_mov_b32 v100, 0
    v_mov_b32 v101, 0
    v_mov_b32 v102, 0
    v_mov_b32 v103, 0
    v_mov_b32 v108, 0x3f803f80
    v_mov_b32 v109, 0
    v_mov_b32 v110, 0x3f803f80
    v_mov_b32 v111, 0
    v_and_b32 v112, 31, v159
    v_cmp_eq_u32 vcc, 24, v112
    s_nop 1
    v_cndmask_b32 v112, v109, v108, vcc
    v_mov_b32 v113, v112
    v_mov_b32 v114, v112
    v_mov_b32 v115, v112
    v_mov_b32 v116, v112
    v_mov_b32 v117, v112
    v_mov_b32 v118, v112
    v_mov_b32 v119, v112
    v_mov_b32 v120, v112
    v_mov_b32 v121, v112
    v_mov_b32 v122, v112
    v_mov_b32 v123, v112
    s_lshr_b32 s43, s24, 2
    s_mov_b32 s48, 0x000fffff
    s_mov_b32 s49, 0x000fffff
    s_mul_i32 s32, s43, 10240
    v_add_u32 v124, s32, v161
    v_add_u32 v130, 8, v124
    v_mul_u32_u24 v125, 320, v160
    v_lshl_add_u32 v125, v159, 4, v125
    v_add_u32 v125, s32, v125
    v_and_b32 v166, 3, v158
    v_lshlrev_b32 v166, 8, v166
    v_add_u32 v166, 4096, v166
    s_lshr_b32 s32, s25, 1
    s_mul_i32 s32, s32, 5120
    s_add_u32 s32, s32, 153600
    s_and_b32 s33, s25, 1
    s_lshl_b32 s33, s33, 11
    s_lshl_b32 s34, s43, 3
    s_add_u32 s33, s33, s34
    s_xor_b32 s34, s33, 8
    s_add_u32 s33, s33, s32
    s_add_u32 s34, s34, s32
    v_add_u32 v126, s33, v161
    v_add_u32 v127, s34, v161
    s_and_b32 s33, s25, 1
    s_lshl_b32 s33, s33, 9
    s_add_u32 s32, s32, s33
    s_add_u32 s32, s32, 4096
    s_lshl_b32 s33, s43, 3
    s_xor_b32 s34, s33, 8
    s_add_u32 s33, s33, s32
    s_add_u32 s34, s34, s32
    v_add_u32 v128, s33, v161
    v_add_u32 v129, s34, v161
    s_cmp_eq_u32 s43, 0
    s_cselect_b32 s45, 5, 6
    s_mov_b32 s42, 231
    s_cmov_b32 s42, 231
.attn212:
    ds_read2st64_b64 v[104:107], v161 offset0:0 offset1:2
    ds_read2st64_b64 v[132:135], v126 offset0:0 offset1:2
    ds_read2st64_b64 v[136:139], v127 offset0:0 offset1:2
    s_mov_b32 exec_hi, 0
    ds_read_b128 v[108:111], v161 offset:4096
    ds_read_b64 v[140:141], v128
    ds_read_b64 v[142:143], v129
    s_mov_b32 exec_hi, -1
    s_waitcnt lgkmcnt(3)
    v_mfma_f32_32x32x16_bf16 v[0:15], v[104:107], v[132:135], 0
    v_mfma_f32_32x32x16_bf16 v[16:31], v[104:107], v[136:139], 0
    s_waitcnt lgkmcnt(0)
    v_mfma_f32_32x32x8_bf16 v[0:15], v[108:109], v[140:141], v[0:15]
    v_mfma_f32_32x32x8_bf16 v[16:31], v[108:109], v[142:143], v[16:31]
    ds_read2st64_b64 v[104:107], v124 offset0:0 offset1:2
    s_mov_b32 exec_hi, 0
    ds_read_b128 v[108:111], v125 offset:4096
    s_mov_b32 exec_hi, -1
    s_mov_b64 exec, s[48:49]
    ds_read_b128 v[112:115], v125 offset:5120
    s_mov_b64 exec, -1
    s_nop 4
    v_max3_f32 v126, v0, v1, v2
    v_max3_f32 v127, v3, v4, v5
    v_max3_f32 v126, v126, v6, v7
    v_max3_f32 v127, v127, v8, v9
    v_max3_f32 v126, v126, v10, v11
    v_max3_f32 v127, v127, v12, v13
    v_max3_f32 v126, v126, v14, v15
    v_max_f32 v126, v126, v127
    v_mov_b32 v127, v126
    s_waitcnt lgkmcnt(0)
    v_mfma_f32_32x32x16_bf16 v[0:15], v[104:107], v[132:135], 0
    v_permlane32_swap_b32 v126, v127
    v_max_f32 v126, v126, v127
    v_cvt_pk_bf16_f32 v127, v126, v126
    v_and_b32 v127, 0xffff0000, v127
    v_sub_f32 v128, v126, v127
    s_mov_b32 exec_lo, 0
    v_cvt_pk_bf16_f32 v140, -v127, -v128
    s_mov_b32 exec_lo, -1
    v_max3_f32 v126, v16, v17, v18
    v_max3_f32 v127, v19, v20, v21
    v_max3_f32 v126, v126, v22, v23
    v_max3_f32 v127, v127, v24, v25
    v_max3_f32 v126, v126, v26, v27
    v_max3_f32 v127, v127, v28, v29
    v_max3_f32 v126, v126, v30, v31
    v_max_f32 v126, v126, v127
    v_mov_b32 v127, v126
    v_mfma_f32_32x32x8_bf16 v[0:15], v[108:109], v[140:141], v[0:15]
    s_nop 0
    v_permlane32_swap_b32 v126, v127
    v_max_f32 v126, v126, v127
    v_cvt_pk_bf16_f32 v127, v126, v126
    v_and_b32 v127, 0xffff0000, v127
    v_sub_f32 v128, v126, v127
    s_mov_b32 exec_lo, 0
    v_cvt_pk_bf16_f32 v142, -v127, -v128
    s_mov_b32 exec_lo, -1
    s_cmp_lg_u32 s41, 1
    s_cbranch_scc1 .nhf74
    s_mov_b32 s41, 0
    s_setprio 3
    s_waitcnt vmcnt(0)
    v_mov_b32 v126, s31
    v_mov_b32 v127, 0
    s_mov_b64 exec, 1
    buffer_store_dword v126, v127, s[8:11], s46 offen sc1
    s_mov_b64 exec, -1
    s_setprio 2
.nhf74:
    s_mov_b32 s38, -1
    s_cmp_ge_u32 s24, 4
    s_cbranch_scc1 .atti76
    s_branch .atti72
.p2align 3
.att71:
    ds_read2st64_b64 v[104:107], v124 offset0:40 offset1:42
    v_exp_f32 v0, v0
    v_exp_f32 v1, v1
    v_exp_f32 v2, v2
    v_exp_f32 v3, v3
    v_cvt_pk_bf16_f32 v96, v0, v1
    v_cvt_pk_bf16_f32 v97, v2, v3
    v_mfma_f32_32x32x16_bf16 v[48:63], v[120:123], v[100:103], v[48:63]
    s_setprio 2
    s_mov_b64 exec, s[48:49]
    ds_read_b128 v[120:123], v125 offset:9600
    ds_read_b128 v[112:115], v125 offset:25600
    s_mov_b64 exec, -1
    v_exp_f32 v4, v4
    v_exp_f32 v5, v5
    v_exp_f32 v6, v6
    v_exp_f32 v7, v7
    v_cvt_pk_bf16_f32 v98, v4, v5
    v_cvt_pk_bf16_f32 v99, v6, v7
    v_mfma_f32_32x32x8_bf16 v[16:31], v[110:111], v[142:143], v[16:31]
    s_mov_b32 exec_hi, 0
    ds_read_b128 v[108:111], v125 offset:24576
    s_mov_b32 exec_hi, -1
    v_exp_f32 v8, v8
    v_exp_f32 v9, v9
    v_exp_f32 v10, v10
    v_exp_f32 v11, v11
    v_cvt_pk_bf16_f32 v100, v8, v9
    v_cvt_pk_bf16_f32 v101, v10, v11
    v_mfma_f32_32x32x16_bf16 v[32:47], v[116:119], v[96:99], v[32:47]
    v_exp_f32 v12, v12
    v_exp_f32 v13, v13
    v_exp_f32 v14, v14
    v_exp_f32 v15, v15
    v_cvt_pk_bf16_f32 v102, v12, v13
    v_cvt_pk_bf16_f32 v103, v14, v15
    s_waitcnt lgkmcnt(0)
    v_mfma_f32_32x32x16_bf16 v[0:15], v[104:107], v[132:135], 0
    v_exp_f32 v16, v16
    v_exp_f32 v17, v17
    v_exp_f32 v18, v18
    v_exp_f32 v19, v19
    v_cvt_pk_bf16_f32 v96, v16, v17
    v_cvt_pk_bf16_f32 v97, v18, v19
    v_mfma_f32_32x32x16_bf16 v[32:47], v[120:123], v[100:103], v[32:47]
    v_add_u32 v124, 20480, v124
    v_add_u32 v130, 20480, v130
    v_add_u32 v125, 20480, v125
    v_exp_f32 v20, v20
    v_exp_f32 v21, v21
    v_exp_f32 v22, v22
    v_exp_f32 v23, v23
    v_cvt_pk_bf16_f32 v98, v20, v21
    v_cvt_pk_bf16_f32 v99, v22, v23
    v_mfma_f32_32x32x8_bf16 v[0:15], v[108:109], v[140:141], v[0:15]
    s_setprio 0
    v_exp_f32 v24, v24
    v_exp_f32 v25, v25
    v_exp_f32 v26, v26
    v_exp_f32 v27, v27
    v_cvt_pk_bf16_f32 v100, v24, v25
    v_cvt_pk_bf16_f32 v101, v26, v27
    v_mfma_f32_32x32x16_bf16 v[48:63], v[116:119], v[96:99], v[48:63]
    v_exp_f32 v28, v28
    v_exp_f32 v29, v29
    v_exp_f32 v30, v30
    v_exp_f32 v31, v31
    v_cvt_pk_bf16_f32 v102, v28, v29
    v_cvt_pk_bf16_f32 v103, v30, v31
.atti72:
    v_mfma_f32_32x32x16_bf16 v[16:31], v[104:107], v[136:139], 0
    ds_read2st64_b64 v[104:107], v130 offset0:0 offset1:2
    v_exp_f32 v0, v0
    v_exp_f32 v1, v1
    v_exp_f32 v2, v2
    v_exp_f32 v3, v3
    v_cvt_pk_bf16_f32 v96, v0, v1
    v_cvt_pk_bf16_f32 v97, v2, v3
    v_mfma_f32_32x32x16_bf16 v[48:63], v[120:123], v[100:103], v[48:63]
    s_setprio 2
    s_mov_b64 exec, s[48:49]
    ds_read_b128 v[120:123], v125 offset:5760
    ds_read_b128 v[116:119], v125 offset:6400
    s_mov_b64 exec, -1
    v_exp_f32 v4, v4
    v_exp_f32 v5, v5
    v_exp_f32 v6, v6
    v_exp_f32 v7, v7
    v_cvt_pk_bf16_f32 v98, v4, v5
    v_cvt_pk_bf16_f32 v99, v6, v7
    v_mfma_f32_32x32x8_bf16 v[16:31], v[108:109], v[142:143], v[16:31]
    v_exp_f32 v8, v8
    v_exp_f32 v9, v9
    v_exp_f32 v10, v10
    v_exp_f32 v11, v11
    v_cvt_pk_bf16_f32 v100, v8, v9
    v_cvt_pk_bf16_f32 v101, v10, v11
    v_mfma_f32_32x32x16_bf16 v[32:47], v[112:115], v[96:99], v[32:47]
    v_exp_f32 v12, v12
    v_exp_f32 v13, v13
    v_exp_f32 v14, v14
    v_exp_f32 v15, v15
    v_cvt_pk_bf16_f32 v102, v12, v13
    v_cvt_pk_bf16_f32 v103, v14, v15
    s_waitcnt lgkmcnt(0)
    v_mfma_f32_32x32x16_bf16 v[0:15], v[104:107], v[132:135], 0
    v_exp_f32 v16, v16
    v_exp_f32 v17, v17
    v_exp_f32 v18, v18
    v_exp_f32 v19, v19
    v_cvt_pk_bf16_f32 v96, v16, v17
    v_cvt_pk_bf16_f32 v97, v18, v19
    v_mfma_f32_32x32x16_bf16 v[32:47], v[120:123], v[100:103], v[32:47]
    v_exp_f32 v20, v20
    v_exp_f32 v21, v21
    v_exp_f32 v22, v22
    v_exp_f32 v23, v23
    v_cvt_pk_bf16_f32 v98, v20, v21
    v_cvt_pk_bf16_f32 v99, v22, v23
    v_mfma_f32_32x32x8_bf16 v[0:15], v[110:111], v[140:141], v[0:15]
    s_setprio 0
    v_exp_f32 v24, v24
    v_exp_f32 v25, v25
    v_exp_f32 v26, v26
    v_exp_f32 v27, v27
    v_cvt_pk_bf16_f32 v100, v24, v25
    v_cvt_pk_bf16_f32 v101, v26, v27
    v_mfma_f32_32x32x16_bf16 v[48:63], v[112:115], v[96:99], v[48:63]
    v_exp_f32 v28, v28
    v_exp_f32 v29, v29
    v_exp_f32 v30, v30
    v_exp_f32 v31, v31
    v_cvt_pk_bf16_f32 v102, v28, v29
    v_cvt_pk_bf16_f32 v103, v30, v31
    v_mfma_f32_32x32x16_bf16 v[16:31], v[104:107], v[136:139], 0
    ds_read2st64_b64 v[104:107], v124 offset0:4 offset1:6
    v_exp_f32 v0, v0
    v_exp_f32 v1, v1
    v_exp_f32 v2, v2
    v_exp_f32 v3, v3
    v_cvt_pk_bf16_f32 v96, v0, v1
    v_cvt_pk_bf16_f32 v97, v2, v3
    v_mfma_f32_32x32x16_bf16 v[48:63], v[120:123], v[100:103], v[48:63]
    s_setprio 2
    s_mov_b64 exec, s[48:49]
    ds_read_b128 v[120:123], v125 offset:7040
    ds_read_b128 v[112:115], v125 offset:7680
    s_mov_b64 exec, -1
    v_exp_f32 v4, v4
    v_exp_f32 v5, v5
    v_exp_f32 v6, v6
    v_exp_f32 v7, v7
    v_cvt_pk_bf16_f32 v98, v4, v5
    v_cvt_pk_bf16_f32 v99, v6, v7
    v_mfma_f32_32x32x8_bf16 v[16:31], v[110:111], v[142:143], v[16:31]
    s_mov_b32 exec_hi, 0
    ds_read_b128 v[108:111], v125 offset:4608
    s_mov_b32 exec_hi, -1
    v_exp_f32 v8, v8
    v_exp_f32 v9, v9
    v_exp_f32 v10, v10
    v_exp_f32 v11, v11
    v_cvt_pk_bf16_f32 v100, v8, v9
    v_cvt_pk_bf16_f32 v101, v10, v11
    v_mfma_f32_32x32x16_bf16 v[32:47], v[116:119], v[96:99], v[32:47]
    v_exp_f32 v12, v12
    v_exp_f32 v13, v13
    v_exp_f32 v14, v14
    v_exp_f32 v15, v15
    v_cvt_pk_bf16_f32 v102, v12, v13
    v_cvt_pk_bf16_f32 v103, v14, v15
    s_waitcnt lgkmcnt(0)
    v_mfma_f32_32x32x16_bf16 v[0:15], v[104:107], v[132:135], 0
    v_exp_f32 v16, v16
    v_exp_f32 v17, v17
    v_exp_f32 v18, v18
    v_exp_f32 v19, v19
    v_cvt_pk_bf16_f32 v96, v16, v17
    v_cvt_pk_bf16_f32 v97, v18, v19
    v_mfma_f32_32x32x16_bf16 v[32:47], v[120:123], v[100:103], v[32:47]
    v_exp_f32 v20, v20
    v_exp_f32 v21, v21
    v_exp_f32 v22, v22
    v_exp_f32 v23, v23
    v_cvt_pk_bf16_f32 v98, v20, v21
    v_cvt_pk_bf16_f32 v99, v22, v23
    v_mfma_f32_32x32x8_bf16 v[0:15], v[108:109], v[140:141], v[0:15]
    s_setprio 0
    v_exp_f32 v24, v24
    v_exp_f32 v25, v25
    v_exp_f32 v26, v26
    v_exp_f32 v27, v27
    v_cvt_pk_bf16_f32 v100, v24, v25
    v_cvt_pk_bf16_f32 v101, v26, v27
    v_mfma_f32_32x32x16_bf16 v[48:63], v[116:119], v[96:99], v[48:63]
    v_exp_f32 v28, v28
    v_exp_f32 v29, v29
    v_exp_f32 v30, v30
    v_exp_f32 v31, v31
    v_cvt_pk_bf16_f32 v102, v28, v29
    v_cvt_pk_bf16_f32 v103, v30, v31
    v_mfma_f32_32x32x16_bf16 v[16:31], v[104:107], v[136:139], 0
    ds_read2st64_b64 v[104:107], v130 offset0:4 offset1:6
    v_exp_f32 v0, v0
    v_exp_f32 v1, v1
    v_exp_f32 v2, v2
    v_exp_f32 v3, v3
    v_cvt_pk_bf16_f32 v96, v0, v1
    v_cvt_pk_bf16_f32 v97, v2, v3
    v_mfma_f32_32x32x16_bf16 v[48:63], v[120:123], v[100:103], v[48:63]
    s_setprio 2
    s_mov_b64 exec, s[48:49]
    ds_read_b128 v[120:123], v125 offset:8320
    ds_read_b128 v[116:119], v125 offset:8960
    s_mov_b64 exec, -1
    v_exp_f32 v4, v4
    v_exp_f32 v5, v5
    v_exp_f32 v6, v6
    v_exp_f32 v7, v7
    v_cvt_pk_bf16_f32 v98, v4, v5
    v_cvt_pk_bf16_f32 v99, v6, v7
    v_mfma_f32_32x32x8_bf16 v[16:31], v[108:109], v[142:143], v[16:31]
    v_exp_f32 v8, v8
    v_exp_f32 v9, v9
    v_exp_f32 v10, v10
    v_exp_f32 v11, v11
    v_cvt_pk_bf16_f32 v100, v8, v9
    v_cvt_pk_bf16_f32 v101, v10, v11
    v_mfma_f32_32x32x16_bf16 v[32:47], v[112:115], v[96:99], v[32:47]
    v_exp_f32 v12, v12
    v_exp_f32 v13, v13
    v_exp_f32 v14, v14
    v_exp_f32 v15, v15
    v_cvt_pk_bf16_f32 v102, v12, v13
    v_cvt_pk_bf16_f32 v103, v14, v15
    s_waitcnt lgkmcnt(0)
    v_mfma_f32_32x32x16_bf16 v[0:15], v[104:107], v[132:135], 0
    v_exp_f32 v16, v16
    v_exp_f32 v17, v17
    v_exp_f32 v18, v18
    v_exp_f32 v19, v19
    v_cvt_pk_bf16_f32 v96, v16, v17
    v_cvt_pk_bf16_f32 v97, v18, v19
    v_mfma_f32_32x32x16_bf16 v[32:47], v[120:123], v[100:103], v[32:47]
    v_exp_f32 v20, v20
    v_exp_f32 v21, v21
    v_exp_f32 v22, v22
    v_exp_f32 v23, v23
    v_cvt_pk_bf16_f32 v98, v20, v21
    v_cvt_pk_bf16_f32 v99, v22, v23
    v_mfma_f32_32x32x8_bf16 v[0:15], v[110:111], v[140:141], v[0:15]
    s_setprio 0
    s_add_u32 s38, s38, 1
    s_bitcmp0_b32 s42, s38
    v_exp_f32 v24, v24
    v_exp_f32 v25, v25
    v_exp_f32 v26, v26
    v_exp_f32 v27, v27
    v_cvt_pk_bf16_f32 v100, v24, v25
    v_cvt_pk_bf16_f32 v101, v26, v27
    v_mfma_f32_32x32x16_bf16 v[48:63], v[112:115], v[96:99], v[48:63]
    v_exp_f32 v28, v28
    v_exp_f32 v29, v29
    v_exp_f32 v30, v30
    v_exp_f32 v31, v31
    v_cvt_pk_bf16_f32 v102, v28, v29
    v_cvt_pk_bf16_f32 v103, v30, v31
    v_mfma_f32_32x32x16_bf16 v[16:31], v[104:107], v[136:139], 0
    s_cbranch_scc1 .att71
    s_branch .atte77
.p2align 3
.att75:
    ds_read2st64_b64 v[104:107], v124 offset0:40 offset1:42
    v_exp_f32 v0, v0
    v_exp_f32 v1, v1
    v_exp_f32 v2, v2
    v_exp_f32 v3, v3
    v_cvt_pk_bf16_f32 v96, v0, v1
    v_cvt_pk_bf16_f32 v97, v2, v3
    v_mfma_f32_32x32x16_bf16 v[48:63], v[120:123], v[100:103], v[48:63]
    s_setprio 1
    s_mov_b64 exec, s[48:49]
    ds_read_b128 v[120:123], v125 offset:9600
    ds_read_b128 v[112:115], v125 offset:25600
    s_mov_b64 exec, -1
    v_exp_f32 v4, v4
    v_exp_f32 v5, v5
    v_exp_f32 v6, v6
    v_exp_f32 v7, v7
    v_cvt_pk_bf16_f32 v98, v4, v5
    v_cvt_pk_bf16_f32 v99, v6, v7
    v_mfma_f32_32x32x8_bf16 v[16:31], v[110:111], v[142:143], v[16:31]
    s_mov_b32 exec_hi, 0
    ds_read_b128 v[108:111], v125 offset:24576
    s_mov_b32 exec_hi, -1
    v_exp_f32 v8, v8
    v_exp_f32 v9, v9
    v_exp_f32 v10, v10
    v_exp_f32 v11, v11
    v_cvt_pk_bf16_f32 v100, v8, v9
    v_cvt_pk_bf16_f32 v101, v10, v11
    v_mfma_f32_32x32x16_bf16 v[32:47], v[116:119], v[96:99], v[32:47]
    v_exp_f32 v12, v12
    v_exp_f32 v13, v13
    v_exp_f32 v14, v14
    v_exp_f32 v15, v15
    v_cvt_pk_bf16_f32 v102, v12, v13
    v_cvt_pk_bf16_f32 v103, v14, v15
    s_waitcnt lgkmcnt(0)
    v_mfma_f32_32x32x16_bf16 v[0:15], v[104:107], v[132:135], 0
    v_exp_f32 v16, v16
    v_exp_f32 v17, v17
    v_exp_f32 v18, v18
    v_exp_f32 v19, v19
    v_cvt_pk_bf16_f32 v96, v16, v17
    v_cvt_pk_bf16_f32 v97, v18, v19
    v_mfma_f32_32x32x16_bf16 v[32:47], v[120:123], v[100:103], v[32:47]
    v_add_u32 v124, 20480, v124
    v_add_u32 v130, 20480, v130
    v_add_u32 v125, 20480, v125
    v_exp_f32 v20, v20
    v_exp_f32 v21, v21
    v_exp_f32 v22, v22
    v_exp_f32 v23, v23
    v_cvt_pk_bf16_f32 v98, v20, v21
    v_cvt_pk_bf16_f32 v99, v22, v23
    v_mfma_f32_32x32x8_bf16 v[0:15], v[108:109], v[140:141], v[0:15]
    v_exp_f32 v24, v24
    v_exp_f32 v25, v25
    v_exp_f32 v26, v26
    v_exp_f32 v27, v27
    v_cvt_pk_bf16_f32 v100, v24, v25
    v_cvt_pk_bf16_f32 v101, v26, v27
    v_mfma_f32_32x32x16_bf16 v[48:63], v[116:119], v[96:99], v[48:63]
    v_exp_f32 v28, v28
    v_exp_f32 v29, v29
    v_exp_f32 v30, v30
    v_exp_f32 v31, v31
    v_cvt_pk_bf16_f32 v102, v28, v29
    v_cvt_pk_bf16_f32 v103, v30, v31
.atti76:
    v_mfma_f32_32x32x16_bf16 v[16:31], v[104:107], v[136:139], 0
    s_setprio 0
    ds_read2st64_b64 v[104:107], v130 offset0:0 offset1:2
    v_exp_f32 v0, v0
    v_exp_f32 v1, v1
    v_exp_f32 v2, v2
    v_exp_f32 v3, v3
    v_cvt_pk_bf16_f32 v96, v0, v1
    v_cvt_pk_bf16_f32 v97, v2, v3
    v_mfma_f32_32x32x16_bf16 v[48:63], v[120:123], v[100:103], v[48:63]
    s_setprio 1
    s_mov_b64 exec, s[48:49]
    ds_read_b128 v[120:123], v125 offset:5760
    ds_read_b128 v[116:119], v125 offset:6400
    s_mov_b64 exec, -1
    v_exp_f32 v4, v4
    v_exp_f32 v5, v5
    v_exp_f32 v6, v6
    v_exp_f32 v7, v7
    v_cvt_pk_bf16_f32 v98, v4, v5
    v_cvt_pk_bf16_f32 v99, v6, v7
    v_mfma_f32_32x32x8_bf16 v[16:31], v[108:109], v[142:143], v[16:31]
    v_exp_f32 v8, v8
    v_exp_f32 v9, v9
    v_exp_f32 v10, v10
    v_exp_f32 v11, v11
    v_cvt_pk_bf16_f32 v100, v8, v9
    v_cvt_pk_bf16_f32 v101, v10, v11
    v_mfma_f32_32x32x16_bf16 v[32:47], v[112:115], v[96:99], v[32:47]
    v_exp_f32 v12, v12
    v_exp_f32 v13, v13
    v_exp_f32 v14, v14
    v_exp_f32 v15, v15
    v_cvt_pk_bf16_f32 v102, v12, v13
    v_cvt_pk_bf16_f32 v103, v14, v15
    s_waitcnt lgkmcnt(0)
    v_mfma_f32_32x32x16_bf16 v[0:15], v[104:107], v[132:135], 0
    v_exp_f32 v16, v16
    v_exp_f32 v17, v17
    v_exp_f32 v18, v18
    v_exp_f32 v19, v19
    v_cvt_pk_bf16_f32 v96, v16, v17
    v_cvt_pk_bf16_f32 v97, v18, v19
    v_mfma_f32_32x32x16_bf16 v[32:47], v[120:123], v[100:103], v[32:47]
    v_exp_f32 v20, v20
    v_exp_f32 v21, v21
    v_exp_f32 v22, v22
    v_exp_f32 v23, v23
    v_cvt_pk_bf16_f32 v98, v20, v21
    v_cvt_pk_bf16_f32 v99, v22, v23
    v_mfma_f32_32x32x8_bf16 v[0:15], v[110:111], v[140:141], v[0:15]
    v_exp_f32 v24, v24
    v_exp_f32 v25, v25
    v_exp_f32 v26, v26
    v_exp_f32 v27, v27
    v_cvt_pk_bf16_f32 v100, v24, v25
    v_cvt_pk_bf16_f32 v101, v26, v27
    v_mfma_f32_32x32x16_bf16 v[48:63], v[112:115], v[96:99], v[48:63]
    v_exp_f32 v28, v28
    v_exp_f32 v29, v29
    v_exp_f32 v30, v30
    v_exp_f32 v31, v31
    v_cvt_pk_bf16_f32 v102, v28, v29
    v_cvt_pk_bf16_f32 v103, v30, v31
    v_mfma_f32_32x32x16_bf16 v[16:31], v[104:107], v[136:139], 0
    s_setprio 0
    ds_read2st64_b64 v[104:107], v124 offset0:4 offset1:6
    v_exp_f32 v0, v0
    v_exp_f32 v1, v1
    v_exp_f32 v2, v2
    v_exp_f32 v3, v3
    v_cvt_pk_bf16_f32 v96, v0, v1
    v_cvt_pk_bf16_f32 v97, v2, v3
    v_mfma_f32_32x32x16_bf16 v[48:63], v[120:123], v[100:103], v[48:63]
    s_setprio 1
    s_mov_b64 exec, s[48:49]
    ds_read_b128 v[120:123], v125 offset:7040
    ds_read_b128 v[112:115], v125 offset:7680
    s_mov_b64 exec, -1
    v_exp_f32 v4, v4
    v_exp_f32 v5, v5
    v_exp_f32 v6, v6
    v_exp_f32 v7, v7
    v_cvt_pk_bf16_f32 v98, v4, v5
    v_cvt_pk_bf16_f32 v99, v6, v7
    v_mfma_f32_32x32x8_bf16 v[16:31], v[110:111], v[142:143], v[16:31]
    s_mov_b32 exec_hi, 0
    ds_read_b128 v[108:111], v125 offset:4608
    s_mov_b32 exec_hi, -1
    v_exp_f32 v8, v8
    v_exp_f32 v9, v9
    v_exp_f32 v10, v10
    v_exp_f32 v11, v11
    v_cvt_pk_bf16_f32 v100, v8, v9
    v_cvt_pk_bf16_f32 v101, v10, v11
    v_mfma_f32_32x32x16_bf16 v[32:47], v[116:119], v[96:99], v[32:47]
    v_exp_f32 v12, v12
    v_exp_f32 v13, v13
    v_exp_f32 v14, v14
    v_exp_f32 v15, v15
    v_cvt_pk_bf16_f32 v102, v12, v13
    v_cvt_pk_bf16_f32 v103, v14, v15
    s_waitcnt lgkmcnt(0)
    v_mfma_f32_32x32x16_bf16 v[0:15], v[104:107], v[132:135], 0
    v_exp_f32 v16, v16
    v_exp_f32 v17, v17
    v_exp_f32 v18, v18
    v_exp_f32 v19, v19
    v_cvt_pk_bf16_f32 v96, v16, v17
    v_cvt_pk_bf16_f32 v97, v18, v19
    v_mfma_f32_32x32x16_bf16 v[32:47], v[120:123], v[100:103], v[32:47]
    v_exp_f32 v20, v20
    v_exp_f32 v21, v21
    v_exp_f32 v22, v22
    v_exp_f32 v23, v23
    v_cvt_pk_bf16_f32 v98, v20, v21
    v_cvt_pk_bf16_f32 v99, v22, v23
    v_mfma_f32_32x32x8_bf16 v[0:15], v[108:109], v[140:141], v[0:15]
    v_exp_f32 v24, v24
    v_exp_f32 v25, v25
    v_exp_f32 v26, v26
    v_exp_f32 v27, v27
    v_cvt_pk_bf16_f32 v100, v24, v25
    v_cvt_pk_bf16_f32 v101, v26, v27
    v_mfma_f32_32x32x16_bf16 v[48:63], v[116:119], v[96:99], v[48:63]
    v_exp_f32 v28, v28
    v_exp_f32 v29, v29
    v_exp_f32 v30, v30
    v_exp_f32 v31, v31
    v_cvt_pk_bf16_f32 v102, v28, v29
    v_cvt_pk_bf16_f32 v103, v30, v31
    v_mfma_f32_32x32x16_bf16 v[16:31], v[104:107], v[136:139], 0
    s_setprio 0
    ds_read2st64_b64 v[104:107], v130 offset0:4 offset1:6
    v_exp_f32 v0, v0
    v_exp_f32 v1, v1
    v_exp_f32 v2, v2
    v_exp_f32 v3, v3
    v_cvt_pk_bf16_f32 v96, v0, v1
    v_cvt_pk_bf16_f32 v97, v2, v3
    v_mfma_f32_32x32x16_bf16 v[48:63], v[120:123], v[100:103], v[48:63]
    s_setprio 1
    s_mov_b64 exec, s[48:49]
    ds_read_b128 v[120:123], v125 offset:8320
    ds_read_b128 v[116:119], v125 offset:8960
    s_mov_b64 exec, -1
    v_exp_f32 v4, v4
    v_exp_f32 v5, v5
    v_exp_f32 v6, v6
    v_exp_f32 v7, v7
    v_cvt_pk_bf16_f32 v98, v4, v5
    v_cvt_pk_bf16_f32 v99, v6, v7
    v_mfma_f32_32x32x8_bf16 v[16:31], v[108:109], v[142:143], v[16:31]
    v_exp_f32 v8, v8
    v_exp_f32 v9, v9
    v_exp_f32 v10, v10
    v_exp_f32 v11, v11
    v_cvt_pk_bf16_f32 v100, v8, v9
    v_cvt_pk_bf16_f32 v101, v10, v11
    v_mfma_f32_32x32x16_bf16 v[32:47], v[112:115], v[96:99], v[32:47]
    v_exp_f32 v12, v12
    v_exp_f32 v13, v13
    v_exp_f32 v14, v14
    v_exp_f32 v15, v15
    v_cvt_pk_bf16_f32 v102, v12, v13
    v_cvt_pk_bf16_f32 v103, v14, v15
    s_waitcnt lgkmcnt(0)
    v_mfma_f32_32x32x16_bf16 v[0:15], v[104:107], v[132:135], 0
    v_exp_f32 v16, v16
    v_exp_f32 v17, v17
    v_exp_f32 v18, v18
    v_exp_f32 v19, v19
    v_cvt_pk_bf16_f32 v96, v16, v17
    v_cvt_pk_bf16_f32 v97, v18, v19
    v_mfma_f32_32x32x16_bf16 v[32:47], v[120:123], v[100:103], v[32:47]
    v_exp_f32 v20, v20
    v_exp_f32 v21, v21
    v_exp_f32 v22, v22
    v_exp_f32 v23, v23
    v_cvt_pk_bf16_f32 v98, v20, v21
    v_cvt_pk_bf16_f32 v99, v22, v23
    v_mfma_f32_32x32x8_bf16 v[0:15], v[110:111], v[140:141], v[0:15]
    s_add_u32 s38, s38, 1
    s_bitcmp0_b32 s42, s38
    v_exp_f32 v24, v24
    v_exp_f32 v25, v25
    v_exp_f32 v26, v26
    v_exp_f32 v27, v27
    v_cvt_pk_bf16_f32 v100, v24, v25
    v_cvt_pk_bf16_f32 v101, v26, v27
    v_mfma_f32_32x32x16_bf16 v[48:63], v[112:115], v[96:99], v[48:63]
    v_exp_f32 v28, v28
    v_exp_f32 v29, v29
    v_exp_f32 v30, v30
    v_exp_f32 v31, v31
    v_cvt_pk_bf16_f32 v102, v28, v29
    v_cvt_pk_bf16_f32 v103, v30, v31
    v_mfma_f32_32x32x16_bf16 v[16:31], v[104:107], v[136:139], 0
    s_setprio 0
    s_cbranch_scc1 .att75
.atte77:
    s_cmp_eq_u32 s38, 7
    s_cbranch_scc1 .attl73
    s_setprio 3
    s_cmp_eq_u32 s41, 0
    s_cbranch_scc1 .evh78
    s_cmp_gt_u32 s38, 1
    s_cbranch_scc1 .eva84
    s_cmp_lt_u32 s38, 1
    s_cbranch_scc1 .evh78
    v_mov_b32 v128, -1
    v_mov_b32 v129, -1
    s_cmp_lt_u32 s24, 4
    s_mov_b32 s35, 4294926336
    s_cmov_b32 s35, 40960
    buffer_store_dwordx2 v[128:129], v167, s[8:11], s62 offen sc1
    buffer_store_dwordx2 v[128:129], v167, s[8:11], s62 offen offset:512 sc1
    s_mov_b32 exec_hi, 0
    buffer_store_dwordx2 v[128:129], v167, s[8:11], s63 offen sc1
    s_mov_b64 exec, -1
    s_add_u32 s62, s62, s35
    s_add_u32 s63, s63, s35
    buffer_store_dwordx2 v[128:129], v167, s[8:11], s62 offen sc1
    buffer_store_dwordx2 v[128:129], v167, s[8:11], s62 offen offset:512 sc1
    s_mov_b32 exec_hi, 0
    buffer_store_dwordx2 v[128:129], v167, s[8:11], s63 offen sc1
    s_mov_b64 exec, -1
    s_sub_u32 s62, s62, s35
    s_sub_u32 s63, s63, s35
    s_branch .evh78
.eva84:
    s_mov_b32 s41, 0
    s_waitcnt vmcnt(0)
    v_mov_b32 v126, s31
    v_mov_b32 v127, 0
    s_mov_b64 exec, 1
    buffer_store_dword v126, v127, s[8:11], s46 offen sc1
    s_mov_b64 exec, -1
.evh78:
    s_lshl_b32 s32, s38, 4
    s_add_u32 s32, s32, 149056
    s_cmp_gt_u32 s38, 1
    s_cmov_b32 s32, 0
    s_cmp_eq_u32 s38, 6
    s_cmov_b32 s32, 112768
    s_cmp_eq_u32 s32, 0
    s_cbranch_scc1 .evb81
    v_and_b32 v126, 3, v158
    v_lshlrev_b32 v126, 2, v126
    v_add_u32 v126, s32, v126
.evs82:
    ds_read_b32 v127, v126
    s_waitcnt lgkmcnt(0)
    v_cmp_ne_u32 vcc, s31, v127
    s_nop 0
    s_cmp_eq_u64 vcc, 0
    s_cbranch_scc1 .evb81
    s_sleep 2
    s_sub_u32 s56, s56, 1
    s_cbranch_scc0 .evs82
    s_mov_b32 s56, 0
.evb81:
    s_cmp_lg_u32 s38, s45
    s_cbranch_scc1 .evx80
    s_cmp_eq_u32 s47, 0
    s_cbranch_scc1 .evw83
    s_mov_b32 s12, s64
    s_mov_b32 s13, s65
    s_mov_b32 s14, 2621440
    s_mov_b32 s15, 0x20000
    s_mov_b32 s16, s78
    s_mov_b32 s17, s79
    s_mov_b32 s18, 1280
    s_mov_b32 s19, 0x20000
    s_lshl_b32 s32, s24, 6
    v_add_u32 v126, s32, v158
    v_mul_u32_u24 v127, 3277, v126
    v_lshrrev_b32 v127, 16, v127
    v_mul_u32_u24 v148, 20, v127
    v_sub_u32 v126, v126, v148
    v_mul_u32_u24 v148, 656, v127
    v_lshl_add_u32 v148, v126, 5, v148
    v_mul_u32_u24 v149, 1280, v127
    v_lshlrev_b32 v127, 4, v127
    s_lshl_b32 s34, s53, 9
    s_add_u32 s34, s34, 22237192
    buffer_load_dword v131, v127, s[8:11], s34 offen sc1
    v_lshlrev_b32 v127, 4, v126
    v_add_u32 v149, v149, v127
    v_cmp_le_u32 s[58:59], 16, v126
    s_mul_i32 s34, s54, 320
    s_mul_i32 s55, s53, 40960
    s_add_u32 s55, s55, s34
    buffer_load_dwordx4 v[150:153], v127, s[16:19], s34 offen
    buffer_load_dwordx4 v[154:157], v149, s[12:15], s55 offen
.evw83:
    s_add_u32 s32, s70, 0
    buffer_load_dwordx4 v[64:67], v161, s[8:11], s32 offen sc1
    s_add_u32 s32, s32, 20480
    buffer_load_dwordx4 v[68:71], v161, s[8:11], s32 offen sc1
    s_add_u32 s32, s32, 20480
    buffer_load_dwordx4 v[72:75], v161, s[8:11], s32 offen sc1
    s_add_u32 s32, s32, 20480
    buffer_load_dwordx4 v[76:79], v161, s[8:11], s32 offen sc1
    s_add_u32 s32, s32, 20480
    buffer_load_dwordx4 v[80:83], v161, s[8:11], s32 offen sc1
    s_add_u32 s32, s32, 20480
    buffer_load_dwordx4 v[84:87], v161, s[8:11], s32 offen sc1
    s_add_u32 s32, s32, 20480
    buffer_load_dwordx4 v[88:91], v161, s[8:11], s32 offen sc1
    s_add_u32 s32, s32, 20480
    buffer_load_dwordx4 v[92:95], v161, s[8:11], s32 offen sc1
    s_add_u32 s32, s32, 20480
    buffer_load_dwordx4 v[144:147], v161, s[8:11], s32 offen sc1
    s_add_u32 s32, s32, 20480
    buffer_load_dwordx4 v[162:165], v161, s[8:11], s32 offen sc1
.evx80:
    s_setprio 0
    s_cmp_lg_u32 s38, 5
    s_cbranch_scc1 .evt79
    s_barrier
.evt79:
    s_cmp_ge_u32 s24, 4
    s_cbranch_scc1 .att75
    s_branch .att71
.attl73:
    s_setprio 3
    buffer_load_dword v139, v166, s[8:11], s3 offen sc1
    s_cmp_lt_u32 s24, 4
    s_cbranch_scc1 .atty85
    s_setprio 0
.atty85:
    v_exp_f32 v0, v0
    v_exp_f32 v1, v1
    v_exp_f32 v2, v2
    v_exp_f32 v3, v3
    v_cvt_pk_bf16_f32 v96, v0, v1
    v_cvt_pk_bf16_f32 v97, v2, v3
    v_mfma_f32_32x32x16_bf16 v[48:63], v[120:123], v[100:103], v[48:63]
    s_mov_b64 exec, s[48:49]
    ds_read_b128 v[120:123], v125 offset:9600
    s_mov_b64 exec, -1
    v_exp_f32 v4, v4
    v_exp_f32 v5, v5
    v_exp_f32 v6, v6
    v_exp_f32 v7, v7
    v_cvt_pk_bf16_f32 v98, v4, v5
    v_cvt_pk_bf16_f32 v99, v6, v7
    v_mfma_f32_32x32x8_bf16 v[16:31], v[110:111], v[142:143], v[16:31]
    v_exp_f32 v8, v8
    v_exp_f32 v9, v9
    v_exp_f32 v10, v10
    v_exp_f32 v11, v11
    v_cvt_pk_bf16_f32 v100, v8, v9
    v_cvt_pk_bf16_f32 v101, v10, v11
    v_mfma_f32_32x32x16_bf16 v[32:47], v[116:119], v[96:99], v[32:47]
    v_exp_f32 v12, v12
    v_exp_f32 v13, v13
    v_exp_f32 v14, v14
    v_exp_f32 v15, v15
    v_cvt_pk_bf16_f32 v102, v12, v13
    v_cvt_pk_bf16_f32 v103, v14, v15
    s_waitcnt lgkmcnt(0)
    v_exp_f32 v16, v16
    v_exp_f32 v17, v17
    v_exp_f32 v18, v18
    v_exp_f32 v19, v19
    v_cvt_pk_bf16_f32 v96, v16, v17
    v_cvt_pk_bf16_f32 v97, v18, v19
    v_mfma_f32_32x32x16_bf16 v[32:47], v[120:123], v[100:103], v[32:47]
    v_exp_f32 v20, v20
    v_exp_f32 v21, v21
    v_exp_f32 v22, v22
    v_exp_f32 v23, v23
    v_cvt_pk_bf16_f32 v98, v20, v21
    v_cvt_pk_bf16_f32 v99, v22, v23
    v_exp_f32 v24, v24
    v_exp_f32 v25, v25
    v_exp_f32 v26, v26
    v_exp_f32 v27, v27
    v_cvt_pk_bf16_f32 v100, v24, v25
    v_cvt_pk_bf16_f32 v101, v26, v27
    v_mfma_f32_32x32x16_bf16 v[48:63], v[116:119], v[96:99], v[48:63]
    v_exp_f32 v28, v28
    v_exp_f32 v29, v29
    v_exp_f32 v30, v30
    v_exp_f32 v31, v31
    v_cvt_pk_bf16_f32 v102, v28, v29
    v_cvt_pk_bf16_f32 v103, v30, v31
    s_nop 0
    s_waitcnt vmcnt(1)
    v_mfma_f32_32x32x16_bf16 v[48:63], v[120:123], v[100:103], v[48:63]
    s_setprio 3
    s_mul_i32 s32, s24, 3328
    s_add_u32 s32, s32, 83968
    s_xor_b32 s33, s24, 4
    s_mul_i32 s33, s33, 3328
    s_add_u32 s33, s33, 83968
    v_add_u32 v124, s32, v161
    v_add_u32 v125, s33, v161
    v_lshlrev_b32 v127, 2, v158
    v_add_u32 v126, s32, v127
    v_add_u32 v127, s33, v127
    s_mov_b32 s35, 1870659584
    s_mov_b32 s34, 813694976
    ds_write_b128 v124, v[48:51]
    ds_write_b128 v124, v[52:55] offset:1024
    ds_write_b128 v124, v[56:59] offset:2048
    ds_write_b32 v126, v60 offset:3072
    s_mov_b32 s43, 2
    s_mov_b32 s44, 0
    s_cmp_ge_u32 s24, 4
    s_cbranch_scc1 .nl88
    s_add_u32 s32, s70, 204800
    buffer_load_dwordx4 v[104:107], v161, s[8:11], s32 offen sc1
    s_add_u32 s32, s32, 20480
    buffer_load_dwordx4 v[108:111], v161, s[8:11], s32 offen sc1
    s_add_u32 s32, s32, 20480
    buffer_load_dwordx4 v[112:115], v161, s[8:11], s32 offen sc1
    s_add_u32 s32, s32, 20480
    buffer_load_dwordx4 v[116:119], v161, s[8:11], s32 offen sc1
    s_add_u32 s32, s32, 20480
    buffer_load_dwordx4 v[132:135], v161, s[8:11], s32 offen sc1
    s_waitcnt vmcnt(5)
    s_branch .nm89
.nl88:
    s_waitcnt vmcnt(0)
.nm89:
    v_cmp_eq_u32 vcc, -1, v139
    s_cmp_ge_u32 s44, 36
    s_cbranch_scc1 .pr92
    s_cmp_lg_u64 vcc, 0
    s_cbranch_scc1 .pp90
.pr92:
    s_mov_b32 s43, 1
    buffer_load_dwordx4 v[0:3], v161, s[8:11], s3 offen offset:0 sc1
    buffer_load_dwordx4 v[4:7], v161, s[8:11], s3 offen offset:1024 sc1
    buffer_load_dwordx4 v[8:11], v161, s[8:11], s3 offen offset:2048 sc1
    buffer_load_dwordx4 v[12:15], v161, s[8:11], s3 offen offset:3072 sc1
    s_add_u32 s32, s3, 4096
    buffer_load_dwordx4 v[16:19], v161, s[8:11], s32 offen sc1
    s_branch .pq91
.pp90:
    buffer_load_dword v139, v166, s[8:11], s3 offen sc1
.pq91:
    s_waitcnt lgkmcnt(0)
    s_barrier
    ds_read_b32 v60, v127 offset:3072
    ds_read_b128 v[48:51], v125
    ds_read_b128 v[52:55], v125 offset:1024
    ds_read_b128 v[56:59], v125 offset:2048
    s_waitcnt lgkmcnt(3)
    v_add_f32 v44, v44, v60
    v_mov_b32 v45, v44
    s_nop 1
    v_permlane32_swap_b32 v44, v45
    s_waitcnt lgkmcnt(0)
    v_pk_add_f32 v[32:33], v[32:33], v[48:49]
    v_pk_add_f32 v[34:35], v[34:35], v[50:51]
    v_pk_add_f32 v[36:37], v[36:37], v[52:53]
    v_pk_add_f32 v[38:39], v[38:39], v[54:55]
    v_pk_add_f32 v[40:41], v[40:41], v[56:57]
    v_pk_add_f32 v[42:43], v[42:43], v[58:59]
    v_maximum3_f32 v126, |v32|, |v33|, |v34|
    v_maximum3_f32 v127, |v35|, |v36|, |v37|
    v_maximum3_f32 v126, v126, |v38|, |v39|
    v_maximum3_f32 v127, v127, |v40|, |v41|
    v_maximum3_f32 v126, v126, |v42|, |v43|
    v_add_f32 v126, v126, v127
    v_fma_f32 v126, 0, v126, v44
    v_cmp_nlt_f32 vcc, v126, s35
    v_cmp_ngt_f32 s[36:37], v126, s34
    s_nop 0
    s_or_b64 vcc, vcc, s[36:37]
    s_cbranch_scc1 .fb86
.out87:
    v_rcp_f32 v126, v44
    s_nop 0
    v_mov_b32 v127, v126
    v_pk_mul_f32 v[32:33], v[32:33], v[126:127]
    v_pk_mul_f32 v[34:35], v[34:35], v[126:127]
    v_pk_mul_f32 v[36:37], v[36:37], v[126:127]
    v_pk_mul_f32 v[38:39], v[38:39], v[126:127]
    v_pk_mul_f32 v[40:41], v[40:41], v[126:127]
    v_pk_mul_f32 v[42:43], v[42:43], v[126:127]
    v_cvt_pk_bf16_f32 v96, v32, v33
    v_cvt_pk_bf16_f32 v97, v34, v35
    v_cvt_pk_bf16_f32 v98, v36, v37
    v_cvt_pk_bf16_f32 v99, v38, v39
    v_cvt_pk_bf16_f32 v100, v40, v41
    v_cvt_pk_bf16_f32 v101, v42, v43
    v_min_u32 v96, -2, v96
    v_min_u32 v97, -2, v97
    v_min_u32 v98, -2, v98
    v_min_u32 v99, -2, v99
    v_min_u32 v100, -2, v100
    v_min_u32 v101, -2, v101
    buffer_store_dwordx2 v[96:97], v167, s[8:11], s62 offen sc1
    buffer_store_dwordx2 v[98:99], v167, s[8:11], s62 offen offset:512 sc1
    s_mov_b32 exec_hi, 0
    buffer_store_dwordx2 v[100:101], v167, s[8:11], s63 offen sc1
    s_mov_b64 exec, -1
    s_setprio 1
    s_mul_i32 s32, s24, 5120
    s_add_u32 s32, s32, 122880
    v_add_u32 v138, s32, v161
    s_lshl_b32 s32, s24, 2
    s_add_u32 s32, s32, 112640
    v_mov_b32 v136, s32
    v_mov_b32 v137, s31
    s_waitcnt vmcnt(3)
.xre94:
    s_cmp_eq_u32 s43, 2
    s_cbranch_scc1 .op96
    v_max3_u32 v128, v0, v1, v2
    v_max3_u32 v129, v3, v4, v5
    v_max3_u32 v129, v129, v6, v7
    v_max3_u32 v128, v128, v8, v9
    v_max3_u32 v129, v129, v10, v11
    v_max3_u32 v128, v128, v12, v13
    v_max3_u32 v129, v129, v14, v15
    v_max3_u32 v128, v128, v16, v17
    v_max3_u32 v129, v129, v18, v19
    v_max_u32 v128, v128, v129
    v_cmp_eq_u32 vcc, -1, v128
    s_nop 0
    s_cmp_lg_u64 vcc, 0
    s_cbranch_scc1 .oa95
    ds_write_b128 v138, v[0:3] offset:0
    ds_write_b128 v138, v[4:7] offset:1024
    ds_write_b128 v138, v[8:11] offset:2048
    ds_write_b128 v138, v[12:15] offset:3072
    ds_write_b128 v138, v[16:19] offset:4096
    s_mov_b32 s43, 0
    s_waitcnt lgkmcnt(0)
    ds_write_b32 v136, v137
    s_branch .gw10
.oa95:
    buffer_load_dwordx4 v[0:3], v161, s[8:11], s3 offen offset:0 sc1
    buffer_load_dwordx4 v[4:7], v161, s[8:11], s3 offen offset:1024 sc1
    buffer_load_dwordx4 v[8:11], v161, s[8:11], s3 offen offset:2048 sc1
    buffer_load_dwordx4 v[12:15], v161, s[8:11], s3 offen offset:3072 sc1
    s_add_u32 s32, s3, 4096
    buffer_load_dwordx4 v[16:19], v161, s[8:11], s32 offen sc1
    s_branch .gw10
.op96:
    v_cmp_eq_u32 vcc, -1, v139
    s_cmp_ge_u32 s44, 36
    s_cbranch_scc1 .pr99
    s_cmp_lg_u64 vcc, 0
    s_cbranch_scc1 .pp97
.pr99:
    s_mov_b32 s43, 1
    buffer_load_dwordx4 v[0:3], v161, s[8:11], s3 offen offset:0 sc1
    buffer_load_dwordx4 v[4:7], v161, s[8:11], s3 offen offset:1024 sc1
    buffer_load_dwordx4 v[8:11], v161, s[8:11], s3 offen offset:2048 sc1
    buffer_load_dwordx4 v[12:15], v161, s[8:11], s3 offen offset:3072 sc1
    s_add_u32 s32, s3, 4096
    buffer_load_dwordx4 v[16:19], v161, s[8:11], s32 offen sc1
    s_branch .pq98
.pp97:
    buffer_load_dword v139, v166, s[8:11], s3 offen sc1
.pq98:
.gw10:
    s_cmp_eq_u32 s43, 1
    s_cbranch_scc1 .gp102
    s_setprio 0
.gp102:
    s_cmp_ge_u32 s24, 10
    s_cbranch_scc1 .ng100
    ds_read_b128 v[28:31], v148 offset:0
    ds_read_b128 v[32:35], v148 offset:16
    ds_read_b128 v[36:39], v148 offset:20992
    ds_read_b128 v[40:43], v148 offset:21008
    ds_read_b128 v[44:47], v148 offset:41984
    ds_read_b128 v[48:51], v148 offset:42000
    ds_read_b128 v[52:55], v148 offset:62976
    ds_read_b128 v[56:59], v148 offset:62992
    s_lshl_b32 s32, s24, 2
    s_add_u32 s32, s32, 112704
    v_mov_b32 v128, s32
    v_mov_b32 v129, s31
    v_and_b32 v131, 0xffff0000, v131
    v_rcp_f32 v131, v131
    s_nop 0
    v_mul_f32 v131, v131, v131
    s_waitcnt lgkmcnt(0)
    ds_write_b32 v128, v129
    v_add_f32 v28, v28, v36
    v_add_f32 v44, v44, v52
    v_add_f32 v29, v29, v37
    v_add_f32 v45, v45, v53
    v_add_f32 v30, v30, v38
    v_add_f32 v46, v46, v54
    v_add_f32 v31, v31, v39
    v_add_f32 v47, v47, v55
    v_add_f32 v32, v32, v40
    v_add_f32 v48, v48, v56
    v_add_f32 v33, v33, v41
    v_add_f32 v49, v49, v57
    v_add_f32 v34, v34, v42
    v_add_f32 v50, v50, v58
    v_add_f32 v35, v35, v43
    v_add_f32 v51, v51, v59
    v_lshlrev_b32 v36, 16, v150
    v_and_b32 v37, 0xffff0000, v150
    v_lshlrev_b32 v38, 16, v151
    v_and_b32 v39, 0xffff0000, v151
    v_lshlrev_b32 v40, 16, v152
    v_and_b32 v41, 0xffff0000, v152
    v_lshlrev_b32 v42, 16, v153
    v_and_b32 v43, 0xffff0000, v153
    v_add_f32 v28, v28, v44
    v_add_f32 v29, v29, v45
    v_add_f32 v30, v30, v46
    v_add_f32 v31, v31, v47
    v_add_f32 v32, v32, v48
    v_add_f32 v33, v33, v49
    v_add_f32 v34, v34, v50
    v_add_f32 v35, v35, v51
    v_fmac_f32 v36, v28, v131
    v_fmac_f32 v37, v29, v131
    v_fmac_f32 v38, v30, v131
    v_fmac_f32 v39, v31, v131
    v_fmac_f32 v40, v32, v131
    v_fmac_f32 v41, v33, v131
    v_fmac_f32 v42, v34, v131
    v_fmac_f32 v43, v35, v131
    v_mul_f32 v28, 3216550459, v36
    v_mul_f32 v29, 3216550459, v37
    v_mul_f32 v30, 3216550459, v38
    v_mul_f32 v31, 3216550459, v39
    v_mul_f32 v32, 3216550459, v40
    v_mul_f32 v33, 3216550459, v41
    v_mul_f32 v34, 3216550459, v42
    v_mul_f32 v35, 3216550459, v43
    v_exp_f32 v28, v28
    v_exp_f32 v29, v29
    v_exp_f32 v30, v30
    v_exp_f32 v31, v31
    v_exp_f32 v32, v32
    v_exp_f32 v33, v33
    v_exp_f32 v34, v34
    v_exp_f32 v35, v35
    v_add_f32 v28, 1.0, v28
    v_add_f32 v29, 1.0, v29
    v_add_f32 v30, 1.0, v30
    v_add_f32 v31, 1.0, v31
    v_add_f32 v32, 1.0, v32
    v_add_f32 v33, 1.0, v33
    v_add_f32 v34, 1.0, v34
    v_add_f32 v35, 1.0, v35
    v_rcp_f32 v28, v28
    v_rcp_f32 v29, v29
    v_rcp_f32 v30, v30
    v_rcp_f32 v31, v31
    v_rcp_f32 v32, v32
    v_rcp_f32 v33, v33
    v_rcp_f32 v34, v34
    v_rcp_f32 v35, v35
    v_mul_f32 v28, v28, v36
    v_mul_f32 v29, v29, v37
    v_mul_f32 v30, v30, v38
    v_mul_f32 v31, v31, v39
    v_mul_f32 v32, v32, v40
    v_mul_f32 v33, v33, v41
    v_mul_f32 v34, v34, v42
    v_mul_f32 v35, v35, v43
    v_cvt_pk_bf16_f32 v150, v28, v29
    v_cvt_pk_bf16_f32 v151, v30, v31
    v_cvt_pk_bf16_f32 v152, v32, v33
    v_cvt_pk_bf16_f32 v153, v34, v35
.ng100:
    s_mov_b32 s20, s80
    s_mov_b32 s21, s81
    s_mov_b32 s22, 2621440
    s_mov_b32 s23, 0x20000
    v_mov_b32 v28, 0
    v_mov_b32 v29, 0
    v_mov_b32 v30, 0
    v_mov_b32 v31, 0
    v_mov_b32 v32, 0
    v_mov_b32 v33, 0
    v_mov_b32 v34, 0
    v_mov_b32 v35, 0
    v_mov_b32 v36, 0
    v_mov_b32 v37, 0
    v_mov_b32 v38, 0
    v_mov_b32 v39, 0
    v_mov_b32 v40, 0
    v_mov_b32 v41, 0
    v_mov_b32 v42, 0
    v_mov_b32 v43, 0
    s_mul_i32 s32, s66, 5120
    s_add_u32 s32, s32, 122880
    v_add_u32 v124, s32, v167
    s_lshr_b32 s32, s24, 2
    s_cmp_eq_u32 s32, 0
    s_cselect_b32 s33, 1, 0
    s_cmp_eq_u32 s32, 1
    s_cselect_b32 s33, s25, s33
    s_cselect_b32 s34, 4, s25
    s_mul_i32 s33, s33, 20992
    s_lshl_b32 s34, s34, 7
    s_add_u32 s33, s33, s34
    v_mul_u32_u24 v125, 656, v159
    v_lshl_add_u32 v125, v160, 4, v125
    v_add_u32 v125, s33, v125
    v_and_b32 v126, 7, v158
    v_lshlrev_b32 v126, 2, v126
    v_add_u32 v126, 112640, v126
    v_min_u32 v140, 9, v158
    v_lshlrev_b32 v140, 2, v140
    v_add_u32 v140, 112704, v140
    s_cmp_lt_u32 s24, 8
    s_cbranch_scc1 .tq110
    s_setprio 1
.tq110:
    s_cmp_eq_u32 s43, 0
    s_cbranch_scc1 .tt103
.ta104:
    s_waitcnt vmcnt(0)
    s_setprio 2
    s_cmp_eq_u32 s43, 2
    s_cbranch_scc1 .op112
    v_max3_u32 v128, v0, v1, v2
    v_max3_u32 v129, v3, v4, v5
    v_max3_u32 v129, v129, v6, v7
    v_max3_u32 v128, v128, v8, v9
    v_max3_u32 v129, v129, v10, v11
    v_max3_u32 v128, v128, v12, v13
    v_max3_u32 v129, v129, v14, v15
    v_max3_u32 v128, v128, v16, v17
    v_max3_u32 v129, v129, v18, v19
    v_max_u32 v128, v128, v129
    v_cmp_eq_u32 vcc, -1, v128
    s_nop 0
    s_cmp_lg_u64 vcc, 0
    s_cbranch_scc1 .oa111
    ds_write_b128 v138, v[0:3] offset:0
    ds_write_b128 v138, v[4:7] offset:1024
    ds_write_b128 v138, v[8:11] offset:2048
    ds_write_b128 v138, v[12:15] offset:3072
    ds_write_b128 v138, v[16:19] offset:4096
    s_mov_b32 s43, 0
    s_waitcnt lgkmcnt(0)
    ds_write_b32 v136, v137
    s_branch .t0109
.oa111:
    buffer_load_dwordx4 v[0:3], v161, s[8:11], s3 offen offset:0 sc1
    buffer_load_dwordx4 v[4:7], v161, s[8:11], s3 offen offset:1024 sc1
    buffer_load_dwordx4 v[8:11], v161, s[8:11], s3 offen offset:2048 sc1
    buffer_load_dwordx4 v[12:15], v161, s[8:11], s3 offen offset:3072 sc1
    s_add_u32 s32, s3, 4096
    buffer_load_dwordx4 v[16:19], v161, s[8:11], s32 offen sc1
    s_branch .t0109
.op112:
    v_cmp_eq_u32 vcc, -1, v139
    s_cmp_ge_u32 s44, 36
    s_cbranch_scc1 .pr115
    s_cmp_lg_u64 vcc, 0
    s_cbranch_scc1 .pp113
.pr115:
    s_mov_b32 s43, 1
    buffer_load_dwordx4 v[0:3], v161, s[8:11], s3 offen offset:0 sc1
    buffer_load_dwordx4 v[4:7], v161, s[8:11], s3 offen offset:1024 sc1
    buffer_load_dwordx4 v[8:11], v161, s[8:11], s3 offen offset:2048 sc1
    buffer_load_dwordx4 v[12:15], v161, s[8:11], s3 offen offset:3072 sc1
    s_add_u32 s32, s3, 4096
    buffer_load_dwordx4 v[16:19], v161, s[8:11], s32 offen sc1
    s_branch .pq114
.pp113:
    buffer_load_dword v139, v166, s[8:11], s3 offen sc1
.pq114:
.t0109:
    s_setprio 0
.tt103:
    ds_read_b32 v128, v126
    s_waitcnt lgkmcnt(0)
    v_cmp_eq_u32 vcc, s31, v128
    s_nop 0
    s_bcnt1_i32_b32 s44, vcc_lo
    s_lshr_b32 s42, vcc_lo, s66
    s_and_b32 s42, s42, s67
    s_cbranch_scc0 .ti106
    s_bitcmp1_b32 s42, 0
    s_cbranch_scc0 .tk116
    ds_read_b64 v[44:45], v124 offset:0
    ds_read_b64 v[46:47], v124 offset:512
    ds_read_b64 v[48:49], v124 offset:1024
    ds_read_b64 v[50:51], v124 offset:1536
    ds_read_b64 v[52:53], v124 offset:2048
    ds_read_b64 v[54:55], v124 offset:2560
    ds_read_b64 v[56:57], v124 offset:3072
    ds_read_b64 v[58:59], v124 offset:3584
    ds_read_b64 v[60:61], v124 offset:4096
    ds_read_b64 v[62:63], v124 offset:4608
    s_waitcnt lgkmcnt(8)
    v_mfma_f32_32x32x16_bf16 v[28:43], v[64:67], v[44:47], v[28:43]
    s_waitcnt lgkmcnt(6)
    v_mfma_f32_32x32x16_bf16 v[28:43], v[68:71], v[48:51], v[28:43]
    s_waitcnt lgkmcnt(4)
    v_mfma_f32_32x32x16_bf16 v[28:43], v[72:75], v[52:55], v[28:43]
    s_waitcnt lgkmcnt(2)
    v_mfma_f32_32x32x16_bf16 v[28:43], v[76:79], v[56:59], v[28:43]
    s_waitcnt lgkmcnt(0)
    v_mfma_f32_32x32x16_bf16 v[28:43], v[80:83], v[60:63], v[28:43]
.tk116:
    s_bitcmp1_b32 s42, 1
    s_cbranch_scc0 .tk117
    ds_read_b64 v[44:45], v124 offset:5120
    ds_read_b64 v[46:47], v124 offset:5632
    ds_read_b64 v[48:49], v124 offset:6144
    ds_read_b64 v[50:51], v124 offset:6656
    ds_read_b64 v[52:53], v124 offset:7168
    ds_read_b64 v[54:55], v124 offset:7680
    ds_read_b64 v[56:57], v124 offset:8192
    ds_read_b64 v[58:59], v124 offset:8704
    ds_read_b64 v[60:61], v124 offset:9216
    ds_read_b64 v[62:63], v124 offset:9728
    s_waitcnt lgkmcnt(8)
    v_mfma_f32_32x32x16_bf16 v[28:43], v[84:87], v[44:47], v[28:43]
    s_waitcnt lgkmcnt(6)
    v_mfma_f32_32x32x16_bf16 v[28:43], v[88:91], v[48:51], v[28:43]
    s_waitcnt lgkmcnt(4)
    v_mfma_f32_32x32x16_bf16 v[28:43], v[92:95], v[52:55], v[28:43]
    s_waitcnt lgkmcnt(2)
    v_mfma_f32_32x32x16_bf16 v[28:43], v[144:147], v[56:59], v[28:43]
    s_waitcnt lgkmcnt(0)
    v_mfma_f32_32x32x16_bf16 v[28:43], v[162:165], v[60:63], v[28:43]
.tk117:
    s_bitcmp1_b32 s42, 2
    s_cbranch_scc0 .tk118
    ds_read_b64 v[44:45], v124 offset:10240
    ds_read_b64 v[46:47], v124 offset:10752
    ds_read_b64 v[48:49], v124 offset:11264
    ds_read_b64 v[50:51], v124 offset:11776
    ds_read_b64 v[52:53], v124 offset:12288
    ds_read_b64 v[54:55], v124 offset:12800
    ds_read_b64 v[56:57], v124 offset:13312
    ds_read_b64 v[58:59], v124 offset:13824
    ds_read_b64 v[60:61], v124 offset:14336
    ds_read_b64 v[62:63], v124 offset:14848
    s_waitcnt lgkmcnt(8)
    v_mfma_f32_32x32x16_bf16 v[28:43], v[104:107], v[44:47], v[28:43]
    s_waitcnt lgkmcnt(6)
    v_mfma_f32_32x32x16_bf16 v[28:43], v[108:111], v[48:51], v[28:43]
    s_waitcnt lgkmcnt(4)
    v_mfma_f32_32x32x16_bf16 v[28:43], v[112:115], v[52:55], v[28:43]
    s_waitcnt lgkmcnt(2)
    v_mfma_f32_32x32x16_bf16 v[28:43], v[116:119], v[56:59], v[28:43]
    s_waitcnt lgkmcnt(0)
    v_mfma_f32_32x32x16_bf16 v[28:43], v[132:135], v[60:63], v[28:43]
.tk118:
    s_bitcmp1_b32 s42, 3
    s_cbranch_scc0 .tk119
    ds_read_b64 v[44:45], v124 offset:15360
    ds_read_b64 v[46:47], v124 offset:15872
    ds_read_b64 v[48:49], v124 offset:16384
    ds_read_b64 v[50:51], v124 offset:16896
    ds_read_b64 v[52:53], v124 offset:17408
    ds_read_b64 v[54:55], v124 offset:17920
    ds_read_b64 v[56:57], v124 offset:18432
    ds_read_b64 v[58:59], v124 offset:18944
    ds_read_b64 v[60:61], v124 offset:19456
    ds_read_b64 v[62:63], v124 offset:19968
    s_waitcnt lgkmcnt(8)
    v_mfma_f32_32x32x16_bf16 v[28:43], v[0:3], v[44:47], v[28:43]
    s_waitcnt lgkmcnt(6)
    v_mfma_f32_32x32x16_bf16 v[28:43], v[4:7], v[48:51], v[28:43]
    s_waitcnt lgkmcnt(4)
    v_mfma_f32_32x32x16_bf16 v[28:43], v[8:11], v[52:55], v[28:43]
    s_waitcnt lgkmcnt(2)
    v_mfma_f32_32x32x16_bf16 v[28:43], v[12:15], v[56:59], v[28:43]
    s_waitcnt lgkmcnt(0)
    v_mfma_f32_32x32x16_bf16 v[28:43], v[16:19], v[60:63], v[28:43]
.tk119:
    s_bitcmp1_b32 s42, 4
    s_cbranch_scc0 .tk120
    ds_read_b64 v[44:45], v124 offset:20480
    ds_read_b64 v[46:47], v124 offset:20992
    ds_read_b64 v[48:49], v124 offset:21504
    ds_read_b64 v[50:51], v124 offset:22016
    ds_read_b64 v[52:53], v124 offset:22528
    ds_read_b64 v[54:55], v124 offset:23040
    ds_read_b64 v[56:57], v124 offset:23552
    ds_read_b64 v[58:59], v124 offset:24064
    ds_read_b64 v[60:61], v124 offset:24576
    ds_read_b64 v[62:63], v124 offset:25088
    s_waitcnt lgkmcnt(8)
    v_mfma_f32_32x32x16_bf16 v[28:43], v[20:23], v[44:47], v[28:43]
    s_waitcnt lgkmcnt(6)
    v_mfma_f32_32x32x16_bf16 v[28:43], v[24:27], v[48:51], v[28:43]
    s_waitcnt lgkmcnt(4)
    v_mfma_f32_32x32x16_bf16 v[28:43], v[96:99], v[52:55], v[28:43]
    s_waitcnt lgkmcnt(2)
    v_mfma_f32_32x32x16_bf16 v[28:43], v[100:103], v[56:59], v[28:43]
    s_waitcnt lgkmcnt(0)
    v_mfma_f32_32x32x16_bf16 v[28:43], v[120:123], v[60:63], v[28:43]
.tk120:
    s_andn2_b32 s67, s67, s42
.ti106:
    s_sub_u32 s56, s56, 1
    s_cbranch_scc1 .tn108
    s_cmp_lg_u32 s43, 0
    s_cbranch_scc1 .ta104
    s_cmp_lg_u32 s67, 0
    s_cbranch_scc1 .tt103
.td105:
    ds_read_b32 v128, v140
    s_waitcnt lgkmcnt(0)
    v_cmp_ne_u32 vcc, s31, v128
    s_nop 1
    s_cmp_eq_u64 vcc, 0
    s_cbranch_scc1 .tn108
    s_sub_u32 s56, s56, 1
    s_cbranch_scc0 .td105
.tn108:
    ds_write_b128 v125, v[28:31] offset:0
    ds_write_b128 v125, v[32:35] offset:32
    ds_write_b128 v125, v[36:39] offset:64
    ds_write_b128 v125, v[40:43] offset:96
    v_mov_b32 v80, 0
    v_mov_b32 v81, 0
    v_mov_b32 v82, 0
    v_mov_b32 v83, 0
    v_mov_b32 v84, 0
    v_mov_b32 v85, 0
    v_mov_b32 v86, 0
    v_mov_b32 v87, 0
    v_mov_b32 v88, 0
    v_mov_b32 v89, 0
    v_mov_b32 v90, 0
    v_mov_b32 v91, 0
    v_mov_b32 v92, 0
    v_mov_b32 v93, 0
    v_mov_b32 v94, 0
    v_mov_b32 v95, 0
    v_lshlrev_b32 v0, 16, v150
    v_and_b32 v1, 0xffff0000, v150
    v_lshlrev_b32 v8, 16, v154
    v_and_b32 v9, 0xffff0000, v154
    v_lshlrev_b32 v2, 16, v151
    v_and_b32 v3, 0xffff0000, v151
    v_lshlrev_b32 v10, 16, v155
    v_and_b32 v11, 0xffff0000, v155
    v_lshlrev_b32 v4, 16, v152
    v_and_b32 v5, 0xffff0000, v152
    v_lshlrev_b32 v12, 16, v156
    v_and_b32 v13, 0xffff0000, v156
    v_lshlrev_b32 v6, 16, v153
    v_and_b32 v7, 0xffff0000, v153
    v_lshlrev_b32 v14, 16, v157
    v_and_b32 v15, 0xffff0000, v157
    s_waitcnt lgkmcnt(0)
    s_barrier
    s_cmp_ge_u32 s24, 10
    s_cbranch_scc1 .fin11
    ds_read_b128 v[64:67], v148 offset:0
    ds_read_b128 v[68:71], v148 offset:16
    ds_read_b128 v[72:75], v148 offset:20992
    ds_read_b128 v[76:79], v148 offset:21008
    s_mov_b64 exec, s[58:59]
    ds_read_b128 v[80:83], v148 offset:41984
    ds_read_b128 v[84:87], v148 offset:42000
    ds_read_b128 v[88:91], v148 offset:62976
    ds_read_b128 v[92:95], v148 offset:62992
    s_mov_b64 exec, -1
    s_waitcnt lgkmcnt(0)
    v_pk_add_f32 v[64:65], v[64:65], v[72:73]
    v_pk_add_f32 v[80:81], v[80:81], v[88:89]
    v_pk_add_f32 v[66:67], v[66:67], v[74:75]
    v_pk_add_f32 v[82:83], v[82:83], v[90:91]
    v_pk_add_f32 v[68:69], v[68:69], v[76:77]
    v_pk_add_f32 v[84:85], v[84:85], v[92:93]
    v_pk_add_f32 v[70:71], v[70:71], v[78:79]
    v_pk_add_f32 v[86:87], v[86:87], v[94:95]
    v_pk_add_f32 v[64:65], v[64:65], v[80:81]
    v_pk_add_f32 v[66:67], v[66:67], v[82:83]
    v_pk_add_f32 v[68:69], v[68:69], v[84:85]
    v_pk_add_f32 v[70:71], v[70:71], v[86:87]
    v_pk_fma_f32 v[8:9], v[64:65], v[0:1], v[8:9]
    v_pk_fma_f32 v[10:11], v[66:67], v[2:3], v[10:11]
    v_pk_fma_f32 v[12:13], v[68:69], v[4:5], v[12:13]
    v_pk_fma_f32 v[14:15], v[70:71], v[6:7], v[14:15]
    v_cvt_pk_bf16_f32 v24, v8, v9
    v_cvt_pk_bf16_f32 v25, v10, v11
    v_cvt_pk_bf16_f32 v26, v12, v13
    v_cvt_pk_bf16_f32 v27, v14, v15
    buffer_store_dwordx4 v[24:27], v149, s[20:23], s55 offen sc1
.fin11:
    s_endpgm
.tr6:
    s_barrier
    s_cmp_lg_u32 s24, 4
    s_cbranch_scc1 .qf128
    s_lshl_b32 s32, s29, 4
    s_add_u32 s32, s32, s28
    s_lshl_b32 s32, s32, 6
    s_add_u32 s32, s32, 22546432
    v_mov_b32 v20, s31
    v_mov_b32 v21, 0
    s_mov_b64 exec, 1
    buffer_store_dword v20, v21, s[8:11], s32 offen sc1
    s_mov_b64 exec, -1
.qf128:
.tr214:
    s_sub_u32 s42, s89, 192
    s_lshl_b32 s42, s42, 3
    s_add_u32 s42, s42, s24
    s_sub_u32 s42, s42, 4
    s_cmp_ge_u32 s89, 240
    s_mov_b32 s4, 1024
    s_cmov_b32 s4, 4294966912
    s_mov_b32 s5, 384
    s_cmov_b32 s5, 128
    s_mov_b32 s6, 1360
    s_cmov_b32 s6, 1024
    s_add_u32 s4, s4, s42
    v_bfe_u32 v5, v158, 2, 2
    v_bfe_u32 v7, v158, 4, 1
    v_and_b32 v8, 3, v158
    v_lshlrev_b32 v7, 6, v7
    v_lshl_add_u32 v7, v8, 4, v7
    v_lshl_add_u32 v8, v160, 2, v5
    v_mad_u32_u24 v9, v160, 20, v5
    v_mul_u32_u24 v8, 1280, v8
    v_mul_u32_u24 v9, 1280, v9
    v_add_u32 v2, v8, v7
    v_add_u32 v3, v9, v7
    s_sub_u32 s46, s24, 4
    s_mul_i32 s46, s46, 18432
    s_mov_b32 s43, s4
    s_mov_b32 s23, 0x20000
    s_mov_b32 m0, s46
    s_cmp_ge_u32 s43, s6
    s_cbranch_scc1 .ptr4127
.ptr121:
    s_mul_i32 s44, s43, 6554
    s_lshr_b32 s44, s44, 16
    s_mul_i32 s32, s44, 10
    s_sub_u32 s45, s43, s32
    s_lshl_b32 s45, s45, 7
    v_mov_b32 v4, v2
    s_mov_b32 s33, 10240
    s_cmp_ge_u32 s44, 96
    s_cbranch_scc1 .pwo122
    s_mov_b32 s20, s76
    s_mov_b32 s21, s77
    s_mov_b32 s22, 1966080
    s_and_b32 s32, s44, 1
    s_lshl_b32 s34, s44, 1
    s_sub_u32 s32, s34, s32
    s_mul_i32 s32, s32, 10240
    s_mov_b32 s33, 20480
    s_branch .pgo124
.pwo122:
    s_mov_b32 s20, s68
    s_mov_b32 s21, s69
    s_mov_b32 s22, 819200
    s_sub_u32 s32, s44, 96
    s_mul_i32 s34, s32, 13108
    s_lshr_b32 s34, s34, 16
    s_mul_i32 s35, s34, 5
    s_sub_u32 s35, s32, s35
    s_cmp_eq_u32 s35, 4
    s_cbranch_scc1 .pex123
    s_sub_u32 s32, s32, s34
    s_mul_i32 s32, s32, 25600
    s_branch .pgo124
.pex123:
    s_mul_i32 s32, s34, 102400
    s_add_u32 s32, s32, 20480
    v_mov_b32 v4, v3
    s_mov_b32 s33, 51200
.pgo124:
    s_add_u32 s32, s32, s45
    s_nop 0
    buffer_load_dwordx4 v4, s[20:23], s32 offen lds
    s_add_u32 m0, m0, 1024
    s_add_u32 s32, s32, s33
    buffer_load_dwordx4 v4, s[20:23], s32 offen lds
    s_add_u32 m0, m0, 1024
    s_add_u32 s43, s43, s5
    s_cmp_lt_u32 s43, s6
    s_cbranch_scc1 .ptr121
    v_lshlrev_b32 v5, 6, v5
    v_lshl_add_u32 v5, v160, 9, v5
    v_bfe_u32 v6, v158, 4, 1
    v_lshl_add_u32 v5, v6, 5, v5
    v_and_b32 v6, 3, v158
    v_lshl_add_u32 v5, v6, 3, v5
    v_add_u32 v5, s46, v5
    s_lshl_b32 s32, s4, 11
    s_add_u32 s32, s32, 14155776
    s_lshl_b32 s33, s5, 11
    s_mov_b32 s43, s4
    s_waitcnt vmcnt(0)
.ptr2125:
    ds_read_b64_tr_b16 v[8:9], v5
    ds_read_b64_tr_b16 v[10:11], v5 offset:1024
    ds_read_b64_tr_b16 v[12:13], v5 offset:256
    ds_read_b64_tr_b16 v[14:15], v5 offset:1280
    v_add_u32 v5, 2048, v5
    s_waitcnt lgkmcnt(0)
    buffer_store_dwordx4 v[8:11], v161, s[8:11], s32 offen sc1
    buffer_store_dwordx4 v[12:15], v161, s[8:11], s32 offen offset:1024 sc1
    s_add_u32 s32, s32, s33
    s_add_u32 s43, s43, s5
    s_cmp_lt_u32 s43, s6
    s_cbranch_scc1 .ptr2125
.ptr4127:
    s_sub_u32 s32, s89, 192
    s_lshl_b32 s32, s32, 6
    s_add_u32 s32, s32, 22673408
    s_waitcnt vmcnt(0)
    s_barrier
    s_cmp_lg_u32 s24, 8
    s_cbranch_scc1 .ptr3126
    v_mov_b32 v16, s31
    v_mov_b32 v17, 0
    s_mov_b64 exec, 1
    buffer_store_dword v16, v17, s[8:11], s32 offen sc1
    s_mov_b64 exec, -1
.ptr3126:
    s_cmp_ge_u32 s24, 8
    s_cbranch_scc1 .trl8
    s_branch .trg27
.stat13:
    s_mov_b32 s12, s64
    s_mov_b32 s13, s65
    s_mov_b32 s14, 2621440
    s_mov_b32 s15, 0x20000
    s_and_b32 s32, s26, 1
    s_lshl_b32 s32, s32, 3
    s_and_b32 s33, s26, 6
    s_add_u32 s32, s32, s33
    s_add_u32 s32, s32, s27
    s_lshl_b32 s32, s32, 3
    s_add_u32 s32, s32, s24
    s_sub_u32 s32, s32, 244
    s_lshl_b32 s42, s32, 4
    s_mul_i32 s32, s42, 1280
    v_lshrrev_b32 v5, 3, v158
    v_and_b32 v7, 7, v158
    v_mul_u32_u24 v6, 1280, v5
    v_lshl_add_u32 v6, v7, 4, v6
    buffer_load_dwordx4 v[32:35], v6, s[12:15], s32 offen offset:0
    buffer_load_dwordx4 v[36:39], v6, s[12:15], s32 offen offset:128
    buffer_load_dwordx4 v[40:43], v6, s[12:15], s32 offen offset:256
    buffer_load_dwordx4 v[44:47], v6, s[12:15], s32 offen offset:384
    buffer_load_dwordx4 v[48:51], v6, s[12:15], s32 offen offset:512
    buffer_load_dwordx4 v[52:55], v6, s[12:15], s32 offen offset:640
    buffer_load_dwordx4 v[56:59], v6, s[12:15], s32 offen offset:768
    buffer_load_dwordx4 v[60:63], v6, s[12:15], s32 offen offset:896
    buffer_load_dwordx4 v[64:67], v6, s[12:15], s32 offen offset:1024
    buffer_load_dwordx4 v[68:71], v6, s[12:15], s32 offen offset:1152
    s_add_u32 s32, s32, 10240
    buffer_load_dwordx4 v[72:75], v6, s[12:15], s32 offen offset:0
    buffer_load_dwordx4 v[76:79], v6, s[12:15], s32 offen offset:128
    buffer_load_dwordx4 v[80:83], v6, s[12:15], s32 offen offset:256
    buffer_load_dwordx4 v[84:87], v6, s[12:15], s32 offen offset:384
    buffer_load_dwordx4 v[88:91], v6, s[12:15], s32 offen offset:512
    buffer_load_dwordx4 v[92:95], v6, s[12:15], s32 offen offset:640
    buffer_load_dwordx4 v[96:99], v6, s[12:15], s32 offen offset:768
    buffer_load_dwordx4 v[100:103], v6, s[12:15], s32 offen offset:896
    buffer_load_dwordx4 v[104:107], v6, s[12:15], s32 offen offset:1024
    buffer_load_dwordx4 v[108:111], v6, s[12:15], s32 offen offset:1152
    s_mov_b32 s20, s82
    s_mov_b32 s21, s83
    s_mov_b32 s22, 256
    s_mov_b32 s23, 0x20000
    v_mov_b32 v3, 0
    buffer_load_dword v13, v3, s[20:23], 0 offen sc1
    v_mov_b32 v12, 0x3f803f80
    v_cmp_eq_u32 s[44:45], 1, v7
    v_lshlrev_b32 v5, 4, v5
    s_lshl_b32 s42, s42, 4
    s_add_u32 s42, s42, 22237184
    s_mov_b32 s43, 986500301
    v_mov_b32 v16, 0
    v_mov_b32 v17, 0
    v_mov_b32 v18, 0
    v_mov_b32 v19, 0
    s_waitcnt vmcnt(16)
    v_dot2c_f32_bf16 v16, v32, v12
    v_dot2c_f32_bf16 v18, v32, v32
    v_dot2c_f32_bf16 v17, v33, v12
    v_dot2c_f32_bf16 v19, v33, v33
    v_dot2c_f32_bf16 v16, v34, v12
    v_dot2c_f32_bf16 v18, v34, v34
    v_dot2c_f32_bf16 v17, v35, v12
    v_dot2c_f32_bf16 v19, v35, v35
    v_dot2c_f32_bf16 v16, v36, v12
    v_dot2c_f32_bf16 v18, v36, v36
    v_dot2c_f32_bf16 v17, v37, v12
    v_dot2c_f32_bf16 v19, v37, v37
    v_dot2c_f32_bf16 v16, v38, v12
    v_dot2c_f32_bf16 v18, v38, v38
    v_dot2c_f32_bf16 v17, v39, v12
    v_dot2c_f32_bf16 v19, v39, v39
    v_dot2c_f32_bf16 v16, v40, v12
    v_dot2c_f32_bf16 v18, v40, v40
    v_dot2c_f32_bf16 v17, v41, v12
    v_dot2c_f32_bf16 v19, v41, v41
    v_dot2c_f32_bf16 v16, v42, v12
    v_dot2c_f32_bf16 v18, v42, v42
    v_dot2c_f32_bf16 v17, v43, v12
    v_dot2c_f32_bf16 v19, v43, v43
    v_dot2c_f32_bf16 v16, v44, v12
    v_dot2c_f32_bf16 v18, v44, v44
    v_dot2c_f32_bf16 v17, v45, v12
    v_dot2c_f32_bf16 v19, v45, v45
    v_dot2c_f32_bf16 v16, v46, v12
    v_dot2c_f32_bf16 v18, v46, v46
    v_dot2c_f32_bf16 v17, v47, v12
    v_dot2c_f32_bf16 v19, v47, v47
    v_dot2c_f32_bf16 v16, v48, v12
    v_dot2c_f32_bf16 v18, v48, v48
    v_dot2c_f32_bf16 v17, v49, v12
    v_dot2c_f32_bf16 v19, v49, v49
    v_dot2c_f32_bf16 v16, v50, v12
    v_dot2c_f32_bf16 v18, v50, v50
    v_dot2c_f32_bf16 v17, v51, v12
    v_dot2c_f32_bf16 v19, v51, v51
    s_waitcnt vmcnt(11)
    v_dot2c_f32_bf16 v16, v52, v12
    v_dot2c_f32_bf16 v18, v52, v52
    v_dot2c_f32_bf16 v17, v53, v12
    v_dot2c_f32_bf16 v19, v53, v53
    v_dot2c_f32_bf16 v16, v54, v12
    v_dot2c_f32_bf16 v18, v54, v54
    v_dot2c_f32_bf16 v17, v55, v12
    v_dot2c_f32_bf16 v19, v55, v55
    v_dot2c_f32_bf16 v16, v56, v12
    v_dot2c_f32_bf16 v18, v56, v56
    v_dot2c_f32_bf16 v17, v57, v12
    v_dot2c_f32_bf16 v19, v57, v57
    v_dot2c_f32_bf16 v16, v58, v12
    v_dot2c_f32_bf16 v18, v58, v58
    v_dot2c_f32_bf16 v17, v59, v12
    v_dot2c_f32_bf16 v19, v59, v59
    v_dot2c_f32_bf16 v16, v60, v12
    v_dot2c_f32_bf16 v18, v60, v60
    v_dot2c_f32_bf16 v17, v61, v12
    v_dot2c_f32_bf16 v19, v61, v61
    v_dot2c_f32_bf16 v16, v62, v12
    v_dot2c_f32_bf16 v18, v62, v62
    v_dot2c_f32_bf16 v17, v63, v12
    v_dot2c_f32_bf16 v19, v63, v63
    v_dot2c_f32_bf16 v16, v64, v12
    v_dot2c_f32_bf16 v18, v64, v64
    v_dot2c_f32_bf16 v17, v65, v12
    v_dot2c_f32_bf16 v19, v65, v65
    v_dot2c_f32_bf16 v16, v66, v12
    v_dot2c_f32_bf16 v18, v66, v66
    v_dot2c_f32_bf16 v17, v67, v12
    v_dot2c_f32_bf16 v19, v67, v67
    v_dot2c_f32_bf16 v16, v68, v12
    v_dot2c_f32_bf16 v18, v68, v68
    v_dot2c_f32_bf16 v17, v69, v12
    v_dot2c_f32_bf16 v19, v69, v69
    v_dot2c_f32_bf16 v16, v70, v12
    v_dot2c_f32_bf16 v18, v70, v70
    v_dot2c_f32_bf16 v17, v71, v12
    v_dot2c_f32_bf16 v19, v71, v71
    s_nop 2
    v_add_f32 v16, v16, v17
    v_add_f32 v18, v18, v19
    s_nop 1
    v_add_f32_dpp v16, v16, v16 quad_perm:[1,0,3,2] row_mask:0xf bank_mask:0xf
    v_add_f32_dpp v18, v18, v18 quad_perm:[1,0,3,2] row_mask:0xf bank_mask:0xf
    s_nop 1
    v_add_f32_dpp v16, v16, v16 quad_perm:[2,3,0,1] row_mask:0xf bank_mask:0xf
    v_add_f32_dpp v18, v18, v18 quad_perm:[2,3,0,1] row_mask:0xf bank_mask:0xf
    s_nop 1
    v_add_f32_dpp v16, v16, v16 row_half_mirror row_mask:0xf bank_mask:0xf
    v_add_f32_dpp v18, v18, v18 row_half_mirror row_mask:0xf bank_mask:0xf
    v_mul_f32 v16, s43, v16
    v_mul_f32 v18, s43, v18
    v_fma_f32 v18, -v16, v16, v18
    v_max_f32 v18, 0, v18
    v_cvt_pk_bf16_f32 v18, v18, v18
    v_and_b32 v18, 0xffff0000, v18
    v_add_f32 v18, 925353388, v18
    v_cvt_pk_bf16_f32 v18, v18, v18
    v_and_b32 v18, 0xffff0000, v18
    v_sqrt_f32 v18, v18
    v_cvt_pk_bf16_f32 v20, -v16, -v16
    v_cvt_pk_bf16_f32 v22, -v16, v18
    v_mov_b32 v24, 0
    v_mov_b32 v25, 0
    v_mov_b32 v26, 0
    v_mov_b32 v27, 0
    s_waitcnt vmcnt(6)
    v_dot2c_f32_bf16 v24, v72, v12
    v_dot2c_f32_bf16 v26, v72, v72
    v_dot2c_f32_bf16 v25, v73, v12
    v_dot2c_f32_bf16 v27, v73, v73
    v_dot2c_f32_bf16 v24, v74, v12
    v_dot2c_f32_bf16 v26, v74, v74
    v_dot2c_f32_bf16 v25, v75, v12
    v_dot2c_f32_bf16 v27, v75, v75
    v_dot2c_f32_bf16 v24, v76, v12
    v_dot2c_f32_bf16 v26, v76, v76
    v_dot2c_f32_bf16 v25, v77, v12
    v_dot2c_f32_bf16 v27, v77, v77
    v_dot2c_f32_bf16 v24, v78, v12
    v_dot2c_f32_bf16 v26, v78, v78
    v_dot2c_f32_bf16 v25, v79, v12
    v_dot2c_f32_bf16 v27, v79, v79
    v_dot2c_f32_bf16 v24, v80, v12
    v_dot2c_f32_bf16 v26, v80, v80
    v_dot2c_f32_bf16 v25, v81, v12
    v_dot2c_f32_bf16 v27, v81, v81
    v_dot2c_f32_bf16 v24, v82, v12
    v_dot2c_f32_bf16 v26, v82, v82
    v_dot2c_f32_bf16 v25, v83, v12
    v_dot2c_f32_bf16 v27, v83, v83
    v_dot2c_f32_bf16 v24, v84, v12
    v_dot2c_f32_bf16 v26, v84, v84
    v_dot2c_f32_bf16 v25, v85, v12
    v_dot2c_f32_bf16 v27, v85, v85
    v_dot2c_f32_bf16 v24, v86, v12
    v_dot2c_f32_bf16 v26, v86, v86
    v_dot2c_f32_bf16 v25, v87, v12
    v_dot2c_f32_bf16 v27, v87, v87
    v_dot2c_f32_bf16 v24, v88, v12
    v_dot2c_f32_bf16 v26, v88, v88
    v_dot2c_f32_bf16 v25, v89, v12
    v_dot2c_f32_bf16 v27, v89, v89
    v_dot2c_f32_bf16 v24, v90, v12
    v_dot2c_f32_bf16 v26, v90, v90
    v_dot2c_f32_bf16 v25, v91, v12
    v_dot2c_f32_bf16 v27, v91, v91
    s_waitcnt vmcnt(1)
    v_dot2c_f32_bf16 v24, v92, v12
    v_dot2c_f32_bf16 v26, v92, v92
    v_dot2c_f32_bf16 v25, v93, v12
    v_dot2c_f32_bf16 v27, v93, v93
    v_dot2c_f32_bf16 v24, v94, v12
    v_dot2c_f32_bf16 v26, v94, v94
    v_dot2c_f32_bf16 v25, v95, v12
    v_dot2c_f32_bf16 v27, v95, v95
    v_dot2c_f32_bf16 v24, v96, v12
    v_dot2c_f32_bf16 v26, v96, v96
    v_dot2c_f32_bf16 v25, v97, v12
    v_dot2c_f32_bf16 v27, v97, v97
    v_dot2c_f32_bf16 v24, v98, v12
    v_dot2c_f32_bf16 v26, v98, v98
    v_dot2c_f32_bf16 v25, v99, v12
    v_dot2c_f32_bf16 v27, v99, v99
    v_dot2c_f32_bf16 v24, v100, v12
    v_dot2c_f32_bf16 v26, v100, v100
    v_dot2c_f32_bf16 v25, v101, v12
    v_dot2c_f32_bf16 v27, v101, v101
    v_dot2c_f32_bf16 v24, v102, v12
    v_dot2c_f32_bf16 v26, v102, v102
    v_dot2c_f32_bf16 v25, v103, v12
    v_dot2c_f32_bf16 v27, v103, v103
    v_dot2c_f32_bf16 v24, v104, v12
    v_dot2c_f32_bf16 v26, v104, v104
    v_dot2c_f32_bf16 v25, v105, v12
    v_dot2c_f32_bf16 v27, v105, v105
    v_dot2c_f32_bf16 v24, v106, v12
    v_dot2c_f32_bf16 v26, v106, v106
    v_dot2c_f32_bf16 v25, v107, v12
    v_dot2c_f32_bf16 v27, v107, v107
    v_dot2c_f32_bf16 v24, v108, v12
    v_dot2c_f32_bf16 v26, v108, v108
    v_dot2c_f32_bf16 v25, v109, v12
    v_dot2c_f32_bf16 v27, v109, v109
    v_dot2c_f32_bf16 v24, v110, v12
    v_dot2c_f32_bf16 v26, v110, v110
    v_dot2c_f32_bf16 v25, v111, v12
    v_dot2c_f32_bf16 v27, v111, v111
    s_nop 2
    v_add_f32 v24, v24, v25
    v_add_f32 v26, v26, v27
    s_nop 1
    v_add_f32_dpp v24, v24, v24 quad_perm:[1,0,3,2] row_mask:0xf bank_mask:0xf
    v_add_f32_dpp v26, v26, v26 quad_perm:[1,0,3,2] row_mask:0xf bank_mask:0xf
    s_nop 1
    v_add_f32_dpp v24, v24, v24 quad_perm:[2,3,0,1] row_mask:0xf bank_mask:0xf
    v_add_f32_dpp v26, v26, v26 quad_perm:[2,3,0,1] row_mask:0xf bank_mask:0xf
    s_nop 1
    v_add_f32_dpp v24, v24, v24 row_half_mirror row_mask:0xf bank_mask:0xf
    v_add_f32_dpp v26, v26, v26 row_half_mirror row_mask:0xf bank_mask:0xf
    v_mul_f32 v24, s43, v24
    v_mul_f32 v26, s43, v26
    v_fma_f32 v26, -v24, v24, v26
    v_max_f32 v26, 0, v26
    v_cvt_pk_bf16_f32 v26, v26, v26
    v_and_b32 v26, 0xffff0000, v26
    v_add_f32 v26, 925353388, v26
    v_cvt_pk_bf16_f32 v26, v26, v26
    v_and_b32 v26, 0xffff0000, v26
    v_sqrt_f32 v26, v26
    v_cvt_pk_bf16_f32 v28, -v24, -v24
    v_cvt_pk_bf16_f32 v30, -v24, v26
    s_waitcnt vmcnt(0)
    v_readfirstlane_b32 s31, v13
    s_waitcnt lgkmcnt(0)
    s_cmp_lg_u32 s31, 0
    s_cbranch_scc1 .npd130
    s_mov_b32 s20, s82
    s_mov_b32 s21, s83
    s_mov_b32 s22, 256
    s_mov_b32 s23, 0x20000
    v_mov_b32 v3, 0
.np129:
    buffer_load_dword v2, v3, s[20:23], 0 offen sc1
    s_waitcnt vmcnt(0)
    v_readfirstlane_b32 s31, v2
    s_cmp_lg_u32 s31, 0
    s_cbranch_scc1 .npd130
    s_sleep 2
    s_sub_u32 s56, s56, 1
    s_cbranch_scc0 .np129
    s_mov_b32 s56, 0
.npd130:
    v_mov_b32 v3, 148992
    v_mov_b32 v2, s31
    ds_write_b32 v3, v2
    v_lshlrev_b32 v7, 5, v7
    s_mov_b64 exec, s[44:45]
    v_mov_b32 v20, v28
    v_mov_b32 v22, v30
    s_mov_b64 exec, -1
    v_bfe_u32 v8, v158, 3, 1
    v_lshl_add_u32 v7, v8, 2, v7
    ds_bpermute_b32 v24, v7, v20
    ds_bpermute_b32 v26, v7, v22
    v_mov_b32 v25, s31
    v_mov_b32 v27, s31
    s_mov_b64 exec, 0xffff
    s_waitcnt lgkmcnt(0)
    buffer_store_dwordx4 v[24:27], v161, s[8:11], s42 offen sc1
    s_mov_b64 exec, -1
    s_barrier
    s_branch .tr214
.poll20:
    s_cmp_eq_u32 s56, 0
    s_cbranch_scc1 .polld22
    s_sub_u32 s56, s56, 1
    s_sleep 1
    buffer_load_dword v140, v139, s[8:11], s46 offen sc1
    s_waitcnt vmcnt(0)
    s_branch .pollc21
.poll23:
    s_cmp_eq_u32 s56, 0
    s_cbranch_scc1 .polld25
    s_sub_u32 s56, s56, 1
    s_sleep 1
    buffer_load_dword v140, v138, s[8:11], s44 offen sc1
    s_waitcnt vmcnt(0)
    s_branch .pollc24
.poll27:
    s_cmp_eq_u32 s56, 0
    s_cbranch_scc1 .polld29
    s_sub_u32 s56, s56, 1
    s_sleep 1
    buffer_load_dword v139, v138, s[8:11], s46 offen sc1
    s_waitcnt vmcnt(0)
    s_branch .pollc28
.poll31:
    s_cmp_eq_u32 s56, 0
    s_cbranch_scc1 .polld33
    s_sub_u32 s56, s56, 1
    s_sleep 1
    buffer_load_dword v30, v28, s[8:11], s32 offen sc1
    buffer_load_dword v31, v28, s[8:11], s33 offen sc1
    buffer_load_dword v32, v28, s[8:11], s34 offen sc1
    buffer_load_dword v33, v28, s[8:11], s35 offen sc1
    s_waitcnt vmcnt(0)
    s_branch .pollc32
.poll56:
    s_cmp_eq_u32 s56, 0
    s_cbranch_scc1 .polld58
    s_sub_u32 s56, s56, 1
    s_sleep 1
    buffer_load_dwordx4 v[32:35], v18, s[8:11], s45 offen sc1
    s_waitcnt vmcnt(0)
    s_branch .pollc57
.poll65:
    s_cmp_eq_u32 s56, 0
    s_cbranch_scc1 .polld67
    s_sub_u32 s56, s56, 1
    s_sleep 1
    buffer_load_dwordx2 v[52:53], v19, s[8:11], s44 offen offset:0 sc1
    buffer_load_dwordx2 v[54:55], v19, s[8:11], s44 offen offset:1024 sc1
    buffer_load_dwordx2 v[56:57], v19, s[8:11], s44 offen offset:2048 sc1
    buffer_load_dwordx2 v[58:59], v19, s[8:11], s44 offen offset:3072 sc1
    s_add_u32 s32, s44, 4096
    buffer_load_dwordx2 v[60:61], v19, s[8:11], s32 offen sc1
    s_waitcnt vmcnt(0)
    s_branch .pollc66
.poll68:
    s_cmp_eq_u32 s56, 0
    s_cbranch_scc1 .polld70
    s_sub_u32 s56, s56, 1
    s_sleep 1
    buffer_load_dword v29, v28, s[8:11], s45 offen sc1
    buffer_load_dword v30, v31, s[8:11], s46 offen sc1
    s_waitcnt vmcnt(0)
    s_branch .pollc69
.fb86:
    s_waitcnt vmcnt(0)
    s_lshr_b32 s37, s24, 2
    s_lshr_b32 s52, s27, 2
    s_lshl_b32 s52, s52, 2
    s_add_u32 s52, s52, s25
    s_lshl_b32 s52, s52, 1
    s_add_u32 s52, s52, s37
    s_lshr_b32 s32, s52, 2
    s_mul_i32 s32, s32, 5120
    s_mul_i32 s33, s50, 81920
    s_add_u32 s32, s32, s33
    s_add_u32 s32, s32, 5242880
    s_and_b32 s33, s52, 3
    s_lshr_b32 s35, s33, 1
    s_lshl_b32 s35, s35, 11
    s_lshl_b32 s34, s37, 3
    s_add_u32 s35, s35, s34
    s_add_u32 s35, s35, s32
    s_lshr_b32 s36, s33, 1
    s_lshl_b32 s36, s36, 9
    s_add_u32 s32, s32, s36
    s_add_u32 s32, s32, 4096
    s_lshl_b32 s33, s37, 3
    s_add_u32 s33, s33, s32
    v_lshlrev_b32 v124, 4, v159
    v_lshl_add_u32 v124, v160, 30, v124
    buffer_load_dwordx2 v[132:133], v161, s[8:11], s35 offen offset:0 sc1
    buffer_load_dwordx2 v[134:135], v161, s[8:11], s35 offen offset:1024 sc1
    buffer_load_dwordx2 v[140:141], v124, s[8:11], s33 offen sc1
    v_mov_b32 v112, 0x3f803f80
    v_mov_b32 v113, 0x3f803f80
    v_mov_b32 v114, 0x3f803f80
    v_mov_b32 v115, 0x3f803f80
    v_mov_b32 v116, 0x3f803f80
    v_mov_b32 v117, 0x3f803f80
    v_mov_b32 v118, 0x3f803f80
    v_mov_b32 v119, 0x3f803f80
    v_mov_b32 v120, 0x3f803f80
    v_mov_b32 v121, 0x3f803f80
    v_mov_b32 v122, 0x3f803f80
    v_mov_b32 v123, 0x3f803f80
    v_mov_b32 v129, 0xff800000
    s_mov_b32 s34, s51
    s_mov_b32 s38, 0
.fa131:
    s_add_u32 s33, s34, 4096
    buffer_load_dwordx4 v[108:111], v124, s[8:11], s33 offen offset:0 sc1
    buffer_load_dwordx2 v[104:105], v161, s[8:11], s34 offen offset:0 sc1
    buffer_load_dwordx2 v[106:107], v161, s[8:11], s34 offen offset:1024 sc1
    s_waitcnt vmcnt(0)
    v_mfma_f32_32x32x16_bf16 v[0:15], v[104:107], v[132:135], 0
    v_mfma_f32_32x32x8_bf16 v[0:15], v[108:109], v[140:141], v[0:15]
    s_nop 15
    v_max3_f32 v126, v0, v1, v2
    v_max3_f32 v127, v3, v4, v5
    v_max3_f32 v126, v126, v6, v7
    v_max3_f32 v127, v127, v8, v9
    v_max3_f32 v126, v126, v10, v11
    v_max3_f32 v127, v127, v12, v13
    v_max3_f32 v126, v126, v14, v15
    v_max_f32 v126, v126, v127
    v_max_f32 v129, v129, v126
    buffer_load_dwordx4 v[108:111], v124, s[8:11], s33 offen offset:0 sc1
    buffer_load_dwordx2 v[104:105], v161, s[8:11], s34 offen offset:8 sc1
    buffer_load_dwordx2 v[106:107], v161, s[8:11], s34 offen offset:1032 sc1
    s_waitcnt vmcnt(0)
    v_mfma_f32_32x32x16_bf16 v[0:15], v[104:107], v[132:135], 0
    v_mfma_f32_32x32x8_bf16 v[0:15], v[110:111], v[140:141], v[0:15]
    s_nop 15
    v_max3_f32 v126, v0, v1, v2
    v_max3_f32 v127, v3, v4, v5
    v_max3_f32 v126, v126, v6, v7
    v_max3_f32 v127, v127, v8, v9
    v_max3_f32 v126, v126, v10, v11
    v_max3_f32 v127, v127, v12, v13
    v_max3_f32 v126, v126, v14, v15
    v_max_f32 v126, v126, v127
    v_max_f32 v129, v129, v126
    buffer_load_dwordx4 v[108:111], v124, s[8:11], s33 offen offset:512 sc1
    buffer_load_dwordx2 v[104:105], v161, s[8:11], s34 offen offset:2048 sc1
    buffer_load_dwordx2 v[106:107], v161, s[8:11], s34 offen offset:3072 sc1
    s_waitcnt vmcnt(0)
    v_mfma_f32_32x32x16_bf16 v[0:15], v[104:107], v[132:135], 0
    v_mfma_f32_32x32x8_bf16 v[0:15], v[108:109], v[140:141], v[0:15]
    s_nop 15
    v_max3_f32 v126, v0, v1, v2
    v_max3_f32 v127, v3, v4, v5
    v_max3_f32 v126, v126, v6, v7
    v_max3_f32 v127, v127, v8, v9
    v_max3_f32 v126, v126, v10, v11
    v_max3_f32 v127, v127, v12, v13
    v_max3_f32 v126, v126, v14, v15
    v_max_f32 v126, v126, v127
    v_max_f32 v129, v129, v126
    buffer_load_dwordx4 v[108:111], v124, s[8:11], s33 offen offset:512 sc1
    buffer_load_dwordx2 v[104:105], v161, s[8:11], s34 offen offset:2056 sc1
    buffer_load_dwordx2 v[106:107], v161, s[8:11], s34 offen offset:3080 sc1
    s_waitcnt vmcnt(0)
    v_mfma_f32_32x32x16_bf16 v[0:15], v[104:107], v[132:135], 0
    v_mfma_f32_32x32x8_bf16 v[0:15], v[110:111], v[140:141], v[0:15]
    s_nop 15
    v_max3_f32 v126, v0, v1, v2
    v_max3_f32 v127, v3, v4, v5
    v_max3_f32 v126, v126, v6, v7
    v_max3_f32 v127, v127, v8, v9
    v_max3_f32 v126, v126, v10, v11
    v_max3_f32 v127, v127, v12, v13
    v_max3_f32 v126, v126, v14, v15
    v_max_f32 v126, v126, v127
    v_max_f32 v129, v129, v126
    s_add_u32 s34, s34, 10240
    s_add_u32 s38, s38, 1
    s_cmp_lt_u32 s38, 16
    s_cbranch_scc1 .fa131
    v_mov_b32 v127, v129
    s_nop 1
    v_permlane32_swap_b32 v129, v127
    v_max_f32 v126, v129, v127
    v_sub_f32 v64, 0, v126
    v_mov_b32 v32, 0
    v_sub_f32 v65, 0, v126
    v_mov_b32 v33, 0
    v_sub_f32 v66, 0, v126
    v_mov_b32 v34, 0
    v_sub_f32 v67, 0, v126
    v_mov_b32 v35, 0
    v_sub_f32 v68, 0, v126
    v_mov_b32 v36, 0
    v_sub_f32 v69, 0, v126
    v_mov_b32 v37, 0
    v_sub_f32 v70, 0, v126
    v_mov_b32 v38, 0
    v_sub_f32 v71, 0, v126
    v_mov_b32 v39, 0
    v_sub_f32 v72, 0, v126
    v_mov_b32 v40, 0
    v_sub_f32 v73, 0, v126
    v_mov_b32 v41, 0
    v_sub_f32 v74, 0, v126
    v_mov_b32 v42, 0
    v_sub_f32 v75, 0, v126
    v_mov_b32 v43, 0
    v_sub_f32 v76, 0, v126
    v_mov_b32 v44, 0
    v_sub_f32 v77, 0, v126
    v_mov_b32 v45, 0
    v_sub_f32 v78, 0, v126
    v_mov_b32 v46, 0
    v_sub_f32 v79, 0, v126
    v_mov_b32 v47, 0
    v_mul_u32_u24 v125, 320, v160
    v_lshl_add_u32 v125, v159, 4, v125
    s_mov_b32 s34, s51
    s_mov_b32 s38, 0
.fbb132:
    s_add_u32 s33, s34, 4096
    s_add_u32 s35, s34, 5120
    buffer_load_dwordx4 v[108:111], v124, s[8:11], s33 offen offset:0 sc1
    buffer_load_dwordx2 v[104:105], v161, s[8:11], s34 offen offset:0 sc1
    buffer_load_dwordx2 v[106:107], v161, s[8:11], s34 offen offset:1024 sc1
    s_mov_b64 exec, s[48:49]
    buffer_load_dwordx4 v[112:115], v125, s[8:11], s35 offen sc1
    buffer_load_dwordx4 v[120:123], v125, s[8:11], s35 offen offset:640 sc1
    s_mov_b64 exec, -1
    s_add_u32 s35, s35, 1280
    s_waitcnt vmcnt(0)
    v_mfma_f32_32x32x16_bf16 v[0:15], v[104:107], v[132:135], v[64:79]
    v_mfma_f32_32x32x8_bf16 v[0:15], v[108:109], v[140:141], v[0:15]
    s_nop 15
    v_exp_f32 v0, v0
    v_exp_f32 v1, v1
    v_exp_f32 v2, v2
    v_exp_f32 v3, v3
    v_cvt_pk_bf16_f32 v96, v0, v1
    v_cvt_pk_bf16_f32 v97, v2, v3
    v_exp_f32 v4, v4
    v_exp_f32 v5, v5
    v_exp_f32 v6, v6
    v_exp_f32 v7, v7
    v_cvt_pk_bf16_f32 v98, v4, v5
    v_cvt_pk_bf16_f32 v99, v6, v7
    v_exp_f32 v8, v8
    v_exp_f32 v9, v9
    v_exp_f32 v10, v10
    v_exp_f32 v11, v11
    v_cvt_pk_bf16_f32 v100, v8, v9
    v_cvt_pk_bf16_f32 v101, v10, v11
    v_exp_f32 v12, v12
    v_exp_f32 v13, v13
    v_exp_f32 v14, v14
    v_exp_f32 v15, v15
    v_cvt_pk_bf16_f32 v102, v12, v13
    v_cvt_pk_bf16_f32 v103, v14, v15
    s_nop 1
    v_mfma_f32_32x32x16_bf16 v[32:47], v[112:115], v[96:99], v[32:47]
    v_mfma_f32_32x32x16_bf16 v[32:47], v[120:123], v[100:103], v[32:47]
    s_nop 15
    buffer_load_dwordx4 v[108:111], v124, s[8:11], s33 offen offset:0 sc1
    buffer_load_dwordx2 v[104:105], v161, s[8:11], s34 offen offset:8 sc1
    buffer_load_dwordx2 v[106:107], v161, s[8:11], s34 offen offset:1032 sc1
    s_mov_b64 exec, s[48:49]
    buffer_load_dwordx4 v[112:115], v125, s[8:11], s35 offen sc1
    buffer_load_dwordx4 v[120:123], v125, s[8:11], s35 offen offset:640 sc1
    s_mov_b64 exec, -1
    s_add_u32 s35, s35, 1280
    s_waitcnt vmcnt(0)
    v_mfma_f32_32x32x16_bf16 v[0:15], v[104:107], v[132:135], v[64:79]
    v_mfma_f32_32x32x8_bf16 v[0:15], v[110:111], v[140:141], v[0:15]
    s_nop 15
    v_exp_f32 v0, v0
    v_exp_f32 v1, v1
    v_exp_f32 v2, v2
    v_exp_f32 v3, v3
    v_cvt_pk_bf16_f32 v96, v0, v1
    v_cvt_pk_bf16_f32 v97, v2, v3
    v_exp_f32 v4, v4
    v_exp_f32 v5, v5
    v_exp_f32 v6, v6
    v_exp_f32 v7, v7
    v_cvt_pk_bf16_f32 v98, v4, v5
    v_cvt_pk_bf16_f32 v99, v6, v7
    v_exp_f32 v8, v8
    v_exp_f32 v9, v9
    v_exp_f32 v10, v10
    v_exp_f32 v11, v11
    v_cvt_pk_bf16_f32 v100, v8, v9
    v_cvt_pk_bf16_f32 v101, v10, v11
    v_exp_f32 v12, v12
    v_exp_f32 v13, v13
    v_exp_f32 v14, v14
    v_exp_f32 v15, v15
    v_cvt_pk_bf16_f32 v102, v12, v13
    v_cvt_pk_bf16_f32 v103, v14, v15
    s_nop 1
    v_mfma_f32_32x32x16_bf16 v[32:47], v[112:115], v[96:99], v[32:47]
    v_mfma_f32_32x32x16_bf16 v[32:47], v[120:123], v[100:103], v[32:47]
    s_nop 15
    buffer_load_dwordx4 v[108:111], v124, s[8:11], s33 offen offset:512 sc1
    buffer_load_dwordx2 v[104:105], v161, s[8:11], s34 offen offset:2048 sc1
    buffer_load_dwordx2 v[106:107], v161, s[8:11], s34 offen offset:3072 sc1
    s_mov_b64 exec, s[48:49]
    buffer_load_dwordx4 v[112:115], v125, s[8:11], s35 offen sc1
    buffer_load_dwordx4 v[120:123], v125, s[8:11], s35 offen offset:640 sc1
    s_mov_b64 exec, -1
    s_add_u32 s35, s35, 1280
    s_waitcnt vmcnt(0)
    v_mfma_f32_32x32x16_bf16 v[0:15], v[104:107], v[132:135], v[64:79]
    v_mfma_f32_32x32x8_bf16 v[0:15], v[108:109], v[140:141], v[0:15]
    s_nop 15
    v_exp_f32 v0, v0
    v_exp_f32 v1, v1
    v_exp_f32 v2, v2
    v_exp_f32 v3, v3
    v_cvt_pk_bf16_f32 v96, v0, v1
    v_cvt_pk_bf16_f32 v97, v2, v3
    v_exp_f32 v4, v4
    v_exp_f32 v5, v5
    v_exp_f32 v6, v6
    v_exp_f32 v7, v7
    v_cvt_pk_bf16_f32 v98, v4, v5
    v_cvt_pk_bf16_f32 v99, v6, v7
    v_exp_f32 v8, v8
    v_exp_f32 v9, v9
    v_exp_f32 v10, v10
    v_exp_f32 v11, v11
    v_cvt_pk_bf16_f32 v100, v8, v9
    v_cvt_pk_bf16_f32 v101, v10, v11
    v_exp_f32 v12, v12
    v_exp_f32 v13, v13
    v_exp_f32 v14, v14
    v_exp_f32 v15, v15
    v_cvt_pk_bf16_f32 v102, v12, v13
    v_cvt_pk_bf16_f32 v103, v14, v15
    s_nop 1
    v_mfma_f32_32x32x16_bf16 v[32:47], v[112:115], v[96:99], v[32:47]
    v_mfma_f32_32x32x16_bf16 v[32:47], v[120:123], v[100:103], v[32:47]
    s_nop 15
    buffer_load_dwordx4 v[108:111], v124, s[8:11], s33 offen offset:512 sc1
    buffer_load_dwordx2 v[104:105], v161, s[8:11], s34 offen offset:2056 sc1
    buffer_load_dwordx2 v[106:107], v161, s[8:11], s34 offen offset:3080 sc1
    s_mov_b64 exec, s[48:49]
    buffer_load_dwordx4 v[112:115], v125, s[8:11], s35 offen sc1
    buffer_load_dwordx4 v[120:123], v125, s[8:11], s35 offen offset:640 sc1
    s_mov_b64 exec, -1
    s_add_u32 s35, s35, 1280
    s_waitcnt vmcnt(0)
    v_mfma_f32_32x32x16_bf16 v[0:15], v[104:107], v[132:135], v[64:79]
    v_mfma_f32_32x32x8_bf16 v[0:15], v[110:111], v[140:141], v[0:15]
    s_nop 15
    v_exp_f32 v0, v0
    v_exp_f32 v1, v1
    v_exp_f32 v2, v2
    v_exp_f32 v3, v3
    v_cvt_pk_bf16_f32 v96, v0, v1
    v_cvt_pk_bf16_f32 v97, v2, v3
    v_exp_f32 v4, v4
    v_exp_f32 v5, v5
    v_exp_f32 v6, v6
    v_exp_f32 v7, v7
    v_cvt_pk_bf16_f32 v98, v4, v5
    v_cvt_pk_bf16_f32 v99, v6, v7
    v_exp_f32 v8, v8
    v_exp_f32 v9, v9
    v_exp_f32 v10, v10
    v_exp_f32 v11, v11
    v_cvt_pk_bf16_f32 v100, v8, v9
    v_cvt_pk_bf16_f32 v101, v10, v11
    v_exp_f32 v12, v12
    v_exp_f32 v13, v13
    v_exp_f32 v14, v14
    v_exp_f32 v15, v15
    v_cvt_pk_bf16_f32 v102, v12, v13
    v_cvt_pk_bf16_f32 v103, v14, v15
    s_nop 1
    v_mfma_f32_32x32x16_bf16 v[32:47], v[112:115], v[96:99], v[32:47]
    v_mfma_f32_32x32x16_bf16 v[32:47], v[120:123], v[100:103], v[32:47]
    s_nop 15
    s_add_u32 s34, s34, 10240
    s_add_u32 s38, s38, 1
    s_cmp_lt_u32 s38, 16
    s_cbranch_scc1 .fbb132
    s_add_u32 s32, s70, 0
    buffer_load_dwordx4 v[64:67], v161, s[8:11], s32 offen sc1
    s_add_u32 s32, s32, 20480
    buffer_load_dwordx4 v[68:71], v161, s[8:11], s32 offen sc1
    s_add_u32 s32, s32, 20480
    buffer_load_dwordx4 v[72:75], v161, s[8:11], s32 offen sc1
    s_add_u32 s32, s32, 20480
    buffer_load_dwordx4 v[76:79], v161, s[8:11], s32 offen sc1
    s_add_u32 s32, s32, 20480
    buffer_load_dwordx4 v[80:83], v161, s[8:11], s32 offen sc1
    s_add_u32 s32, s32, 20480
    buffer_load_dwordx4 v[84:87], v161, s[8:11], s32 offen sc1
    s_add_u32 s32, s32, 20480
    buffer_load_dwordx4 v[88:91], v161, s[8:11], s32 offen sc1
    s_add_u32 s32, s32, 20480
    buffer_load_dwordx4 v[92:95], v161, s[8:11], s32 offen sc1
    s_add_u32 s32, s32, 20480
    buffer_load_dwordx4 v[144:147], v161, s[8:11], s32 offen sc1
    s_add_u32 s32, s32, 20480
    buffer_load_dwordx4 v[162:165], v161, s[8:11], s32 offen sc1
    s_add_u32 s32, s32, 20480
    buffer_load_dwordx4 v[104:107], v161, s[8:11], s32 offen sc1
    s_add_u32 s32, s32, 20480
    buffer_load_dwordx4 v[108:111], v161, s[8:11], s32 offen sc1
    s_add_u32 s32, s32, 20480
    buffer_load_dwordx4 v[112:115], v161, s[8:11], s32 offen sc1
    s_add_u32 s32, s32, 20480
    buffer_load_dwordx4 v[116:119], v161, s[8:11], s32 offen sc1
    s_add_u32 s32, s32, 20480
    buffer_load_dwordx4 v[132:135], v161, s[8:11], s32 offen sc1
    buffer_load_dword v139, v166, s[8:11], s3 offen sc1
    s_mov_b32 s43, 2
    s_branch .out87
.cend9:
.end1:
    s_endpgm
.section .rodata,"a"
.p2align 6
.amdhsa_kernel recurrent_scan__softmax_full_mha__dense_activation_squared_relu__prompt_kernel
  .amdhsa_next_free_vgpr 168
  .amdhsa_next_free_sgpr 102
  .amdhsa_accum_offset 168
  .amdhsa_group_segment_fixed_size 0
  .amdhsa_kernarg_size 88
  .amdhsa_user_sgpr_count 2
  .amdhsa_user_sgpr_kernarg_segment_ptr 1
  .amdhsa_system_sgpr_workgroup_id_x 1
.end_amdhsa_kernel
```
